```python
import torch

def _softmax(x, axis=-1):
    return torch.softmax(x, dim=axis)
def _gelu(x):
    return torch.nn.functional.gelu(x, approximate="tanh")
def _silu(x):
    return torch.nn.functional.silu(x)
def _sigmoid(x):
    return torch.sigmoid(x)
def _layernorm(x, axis=-1, eps=1e-5):
    m = x.mean(dim=axis, keepdim=True)
    v = x.var(dim=axis, keepdim=True, unbiased=False)
    return (x - m) / torch.sqrt(v + eps)
def _scatter_add(tgt, idx, src, axis=0):
    return tgt.clone().index_add_(axis, idx, src)
def _segment_sum(src, seg, n):
    out = torch.zeros((n,) + src.shape[1:], dtype=src.dtype)
    return out.index_add_(0, seg, src)
def _pad(x, pw):
    flat = tuple(v for pair in reversed(pw) for v in pair)
    return torch.nn.functional.pad(x, flat)

kernel_name = 'recurrent_scan__ssm_conv_s5__glu_gated_glu__prompt'

def setup_inputs():

    _w = (lambda a: (lambda t: t.to(torch.bfloat16) if t.is_floating_point() else t)(torch.as_tensor(a)))
    def _A_setup():
        B, S, D = 1, 2048, 640
        P = D
        Lambda_re = -0.5 * (lambda _x: torch.exp(torch.as_tensor(_x)))((lambda *s: torch.randn(*s, dtype=torch.bfloat16) * 0.2)(P))
        Lambda_im = (lambda *s: torch.randn(*s, dtype=torch.bfloat16) * 0.8)(P) * 1.0
        B_re = (lambda *s: torch.randn(*s, dtype=torch.bfloat16) * 0.2)(P, D) * (D ** -0.5)
        B_im = (lambda *s: torch.randn(*s, dtype=torch.bfloat16) * 0.2)(P, D) * (D ** -0.5)
        C_re = (lambda *s: torch.randn(*s, dtype=torch.bfloat16) * 0.2)(D, P) * (P ** -0.5)
        C_im = (lambda *s: torch.randn(*s, dtype=torch.bfloat16) * 0.2)(D, P) * (P ** -0.5)
        log_dt = (lambda *s: torch.randn(*s, dtype=torch.bfloat16) * 0.2)(P) * 0.3 - 2.0
        Dskip = (lambda *s: torch.randn(*s, dtype=torch.bfloat16) * 0.05)(D)
        return {
            "x": _w((lambda *s: torch.randn(*s, dtype=torch.bfloat16) * 0.05)(B, S, D)),
            "Lambda_re": _w(Lambda_re),
            "Lambda_im": _w(Lambda_im),
            "B_re": _w(B_re),
            "B_im": _w(B_im),
            "C_re": _w(C_re),
            "C_im": _w(C_im),
            "log_dt": _w(log_dt),
            "Dskip": _w(Dskip),
        }
    _A_in = _A_setup()

    def _B_setup():
        B, S, D, F = 1, 2048, 640, 1536
        return {
            "x": _w((lambda *s: torch.randn(*s, dtype=torch.bfloat16) * 0.05)(B, S, D)),
            "w_gate": _w((lambda *s: torch.randn(*s, dtype=torch.bfloat16) * 0.05)(D, F)),
            "w_up": _w((lambda *s: torch.randn(*s, dtype=torch.bfloat16) * 0.05)(D, F)),
            "w_down": _w((lambda *s: torch.randn(*s, dtype=torch.bfloat16) * 0.05)(F, D)),
        }
    _B_in = _B_setup()

    return {
        "A_x": _A_in["x"],
        "A_Lambda_re": _A_in["Lambda_re"],
        "A_Lambda_im": _A_in["Lambda_im"],
        "A_B_re": _A_in["B_re"],
        "A_B_im": _A_in["B_im"],
        "A_C_re": _A_in["C_re"],
        "A_C_im": _A_in["C_im"],
        "A_log_dt": _A_in["log_dt"],
        "A_Dskip": _A_in["Dskip"],
        "B_x": _B_in["x"],
        "B_w_gate": _B_in["w_gate"],
        "B_w_up": _B_in["w_up"],
        "B_w_down": _B_in["w_down"],
    }

def reference(A_x, A_Lambda_re, A_Lambda_im, A_B_re, A_B_im, A_C_re, A_C_im, A_log_dt, A_Dskip, B_x, B_w_gate, B_w_up, B_w_down):
    def _A_ref(x, Lambda_re, Lambda_im, B_re, B_im, C_re, C_im, log_dt, Dskip):
        Bsz, L, H = x.shape
        Lam = Lambda_re + 1j * Lambda_im
        Bmat = B_re + 1j * B_im
        Cmat = C_re + 1j * C_im
        dt = torch.exp(log_dt)
        Lam_bar = torch.exp(dt * Lam)
        B_bar = ((Lam_bar - 1.0) / Lam)[:, None] * Bmat
        Bu = torch.einsum("bld,pd->blp", x + 0j, B_bar)
        h = torch.zeros_like(Bu[:, 0, :])
        hs = []
        for t in range(L):
            h = Lam_bar[None, :] * h + Bu[:, t, :]
            hs.append(h)
        hseq = torch.stack(hs, 1)
        y = 2.0 * torch.einsum("blp,dp->bld", hseq, Cmat).real + x * Dskip[None, None, :]
        return y

    def _B_ref(x, w_gate, w_up, w_down):
        g = torch.einsum("bsd,df->bsf", x, w_gate)
        u = torch.einsum("bsd,df->bsf", x, w_up)
        h = _sigmoid(g) * u
        return torch.einsum("bsf,fd->bsd", h, w_down)

    x = A_x
    xn = _layernorm(x, axis=-1)
    s = _A_ref(xn, A_Lambda_re, A_Lambda_im, A_B_re, A_B_im, A_C_re, A_C_im, A_log_dt, A_Dskip)
    g = _silu(_B_ref(xn, B_w_gate, B_w_up, B_w_down))
    return x + s * g
```

```asm
; @launch grid=(256,1,1) block=(256,1,1) lds=163840
.amdgcn_target "amdgcn-amd-amdhsa--gfx950"
.text
.globl recurrent_scan__ssm_conv_s5__glu_gated_glu__prompt_kernel
.p2align 8
.type recurrent_scan__ssm_conv_s5__glu_gated_glu__prompt_kernel,@function
recurrent_scan__ssm_conv_s5__glu_gated_glu__prompt_kernel:
    s_cmp_ge_u32 s2, 256
    s_cbranch_scc1 L_end
    s_load_dwordx16 s[64:79], s[0:1], 0
    s_load_dwordx16 s[80:95], s[0:1], 64
    s_getpc_b64 s[50:51]
L_pc:
    s_lshr_b32 s52, s2, 3
    v_lshrrev_b32 v76, 6, v0
    v_and_b32 v85, 7, v0
    s_lshl_b32 s53, s52, 3
    v_readfirstlane_b32 s36, v76
    v_lshl_add_u32 v77, v76, 8, v85
    v_add_lshl_u32 v77, v77, s53, 7
    v_min_u32 v77, L_code_end-L_pc-4, v77
    v_mov_b32 v79, s51
    v_add_co_u32 v78, vcc, s50, v77
    v_and_b32 v0, 63, v0
    s_nop 0
    v_addc_co_u32 v79, vcc, 0, v79, vcc
    global_load_dword v93, v[78:79], off
    s_and_b32 s37, s2, 1
    s_bfe_u32 s50, s2, 65537
    s_lshl1_add_u32 s37, s37, s50
    s_and_b32 s52, s52, 3
    s_lshl2_add_u32 s37, s37, s52
    s_bfe_u32 s50, s2, 65538
    s_bfe_u32 s51, s2, 65541
    s_lshl1_add_u32 s50, s50, s51
    s_lshr_b32 s51, s2, 6
    s_lshl2_add_u32 s38, s50, s51
    s_lshl2_add_u32 s56, s37, s50
    s_and_b32 s54, s51, 1
    s_lshl1_add_u32 s52, s56, s54
    s_lshr_b32 s55, s36, 1
    s_lshl1_add_u32 s52, s52, s55
    s_lshr_b32 s51, s51, 1
    s_lshl1_add_u32 s52, s52, s51
    s_and_b32 s53, s36, 1
    s_lshl1_add_u32 s52, s52, s53
    s_mul_i32 s52, s52, 2560
    v_lshrrev_b32 v81, 5, v0
    v_and_b32 v82, 31, v0
    v_mul_u32_u24 v83, 1280, v81
    v_lshl_add_u32 v83, v82, 3, v83
    s_mov_b32 s6, 2621440
    s_mov_b32 s7, 0x20000
    s_mov_b32 s18, 819200
    s_mov_b32 s19, 0x20000
    s_mov_b32 s30, 1966080
    s_mov_b32 s31, 0x20000
    v_lshrrev_b32 v84, 3, v0
    v_min_u32 v80, 12, v0
    s_mul_i32 s50, s55, 12
    v_add_u32 v80, s50, v80
    v_mul_u32_u24 v92, 52, v80
    v_lshrrev_b32 v92, 8, v92
    v_mul_u32_u24 v92, 1275, v92
    v_add_lshl_u32 v80, v80, v92, 7
    s_lshl4_add_u32 s97, s38, s37
    s_mul_i32 s97, s97, 640
    v_min_u32 v92, 39, v0
    v_lshrrev_b32 v95, 3, v92
    v_mul_u32_u24 v95, 120, v95
    s_lshl_b32 s50, s38, 3
    v_add3_u32 v92, v92, v95, s50
    v_lshlrev_b32 v92, 1, v92
    s_lshl_b32 s59, s36, 12
    s_cmp_eq_u32 s53, 0
    s_waitcnt lgkmcnt(0)
    s_cselect_b64 s[28:29], s[84:85], s[86:87]
    s_cselect_b64 s[16:17], s[70:71], s[72:73]
    s_mov_b64 s[4:5], s[64:65]
    buffer_load_dwordx2 v[96:97], v83, s[4:7], s52 offen offset:0
    buffer_load_dwordx2 v[98:99], v83, s[4:7], s52 offen offset:256
    buffer_load_dwordx2 v[100:101], v83, s[4:7], s52 offen offset:512
    buffer_load_dwordx2 v[102:103], v83, s[4:7], s52 offen offset:768
    buffer_load_dwordx2 v[104:105], v83, s[4:7], s52 offen offset:1024
    s_load_dword s42, s[94:95], 0
    global_load_ushort v209, v92, s[66:67]
    global_load_ushort v210, v92, s[68:69]
    global_load_ushort v211, v92, s[78:79]
    global_load_ushort v94, v92, s[80:81]
    s_mov_b64 s[8:9], s[94:95]
    s_mov_b32 s10, 268435456
    s_mov_b32 s11, 0x20000
    s_mov_b64 s[32:33], s[88:89]
    s_mov_b32 s34, 1966080
    s_mov_b32 s35, 0x20000
    s_mov_b64 s[20:21], s[74:75]
    s_mov_b32 s22, 819200
    s_mov_b32 s23, 0x20000
    s_mov_b64 s[24:25], s[76:77]
    s_mov_b32 s26, 819200
    s_mov_b32 s27, 0x20000
    s_mov_b64 s[12:13], s[90:91]
    s_mov_b32 s14, 5242880
    s_mov_b32 s15, 0x20000
    s_mov_b64 s[62:63], s[80:81]
    s_branch L_al
.p2align 12
L_al:
    s_mul_i32 s45, s36, 5120
    v_and_b32 v87, 6, v84
    v_xor_b32 v87, v87, v85
    v_xor_b32 v87, s53, v87
    v_mul_u32_u24 v89, 1280, v84
    v_lshl_add_u32 v5, v87, 4, v89
    v_add_u32 v6, 162816, v5
    v_add_u32 v7, 325632, v5
    v_add_u32 v8, 488448, v5
    v_add_u32 v9, 655360, v5
    s_mul_i32 s61, s38, 80
    s_add_u32 s61, s61, s55
    s_lshl_b32 s61, s61, 7
    v_lshlrev_b32 v1, 4, v0
    v_lshrrev_b32 v128, 1, v82
    v_mul_u32_u24 v128, 144, v128
    v_lshl_add_u32 v128, v81, 4, v128
    v_and_b32 v129, 1, v0
    v_lshl_add_u32 v128, v129, 3, v128
    s_lshl_b32 s50, s36, 5
    s_add_u32 s50, s50, 122880
    v_add_u32 v128, s50, v128
    v_mul_u32_u24 v130, 144, v84
    v_lshl_add_u32 v130, v85, 4, v130
    s_mul_i32 s50, s36, 1152
    s_add_u32 s50, s50, 122880
    v_add_u32 v130, s50, v130
    v_and_b32 v131, 3, v84
    v_lshlrev_b32 v131, 8, v131
    v_lshl_add_u32 v131, v81, 11, v131
    v_lshl_add_u32 v131, v85, 4, v131
    s_mul_i32 s98, s56, 320
    s_lshl3_add_u32 s50, s51, s54
    s_add_u32 s98, s98, s50
    s_lshl_b32 s98, s98, 7
    s_add_u32 s98, s98, s59
    s_add_u32 s98, s98, 2097152
    s_add_u32 s99, s98, 16384
    s_add_u32 s100, s98, 32768
    s_cmp_lt_u32 s36, 2
    s_cselect_b32 s100, s100, 2146435072
    s_lshl4_add_u32 s47, s54, s37
    s_lshl1_add_u32 s46, s47, s55
    s_mul_i32 s48, s46, 86
    s_lshr_b32 s48, s48, 8
    s_lshr_b32 s49, s38, 1
    s_sub_u32 s44, s49, s48
    s_mul_i32 s44, s44, 3
    s_add_u32 s44, s44, s46
    s_mul_i32 s93, s48, 768
    s_add_u32 s93, s93, s44
    s_lshl_b32 s93, s93, 7
    s_cmp_lt_u32 s46, 60
    s_cselect_b32 s93, s93, 2146435072
    v_mul_u32_u24 v90, 3072, v84
    v_lshl_add_u32 v90, v85, 4, v90
    s_mul_i32 s101, s44, 80
    s_lshl1_add_u32 s50, s48, s53
    s_add_u32 s101, s101, s50
    s_lshl_b32 s101, s101, 11
    s_add_u32 s101, s101, 4718592
    s_cmp_lt_u32 s46, 60
    s_cselect_b32 s101, s101, 2146435072
    s_add_u32 m0, s59, 102400
    s_nop 0
    buffer_load_dwordx4 v90, s[28:31], s93 offen offset:0 lds
    s_add_u32 s93, s93, 23552
    buffer_load_dwordx4 v90, s[28:31], s93 offen offset:1024 lds
    s_add_u32 s93, s93, 23552
    buffer_load_dwordx4 v90, s[28:31], s93 offen offset:2048 lds
    s_add_u32 s93, s93, 23552
    buffer_load_dwordx4 v90, s[28:31], s93 offen offset:3072 lds
    buffer_load_dword v91, v80, s[16:19], s97 offen
    s_lshl1_add_u32 s50, s2, s53
    s_mul_i32 s91, s50, 6554
    s_lshr_b32 s91, s91, 16
    s_mul_i32 s92, s91, 10
    s_sub_u32 s92, s50, s92
    s_mul_i32 s90, s91, 320
    s_add_u32 s90, s90, s92
    s_lshl_b32 s90, s90, 7
    s_mul_i32 s50, s55, 20480
    s_add_u32 s90, s90, s50
    v_lshl_add_u32 v69, v85, 4, v89
    s_waitcnt vmcnt(13)
    v_lshlrev_b32 v108, 16, v96
    v_and_b32 v109, 0xffff0000, v96
    v_lshlrev_b32 v110, 16, v97
    v_and_b32 v111, 0xffff0000, v97
    s_waitcnt vmcnt(12)
    v_lshlrev_b32 v112, 16, v98
    v_and_b32 v113, 0xffff0000, v98
    v_lshlrev_b32 v114, 16, v99
    v_and_b32 v115, 0xffff0000, v99
    s_waitcnt vmcnt(11)
    v_lshlrev_b32 v116, 16, v100
    v_and_b32 v117, 0xffff0000, v100
    v_lshlrev_b32 v118, 16, v101
    v_and_b32 v119, 0xffff0000, v101
    s_waitcnt vmcnt(10)
    v_lshlrev_b32 v120, 16, v102
    v_and_b32 v121, 0xffff0000, v102
    v_lshlrev_b32 v122, 16, v103
    v_and_b32 v123, 0xffff0000, v103
    s_waitcnt vmcnt(9)
    v_lshlrev_b32 v124, 16, v104
    v_and_b32 v125, 0xffff0000, v104
    v_lshlrev_b32 v126, 16, v105
    v_and_b32 v127, 0xffff0000, v105
    v_pk_add_f32 v[132:133], v[108:109], v[110:111]
    v_pk_add_f32 v[134:135], v[112:113], v[114:115]
    v_pk_add_f32 v[132:133], v[132:133], v[116:117]
    v_pk_add_f32 v[134:135], v[134:135], v[118:119]
    v_pk_add_f32 v[132:133], v[132:133], v[120:121]
    v_pk_add_f32 v[134:135], v[134:135], v[122:123]
    v_pk_add_f32 v[132:133], v[132:133], v[124:125]
    v_pk_add_f32 v[134:135], v[134:135], v[126:127]
    v_pk_add_f32 v[132:133], v[132:133], v[134:135]
    v_add_f32 v132, v132, v133
    s_nop 1
    v_add_f32_dpp v132, v132, v132 quad_perm:[1,0,3,2] row_mask:0xf bank_mask:0xf
    s_nop 1
    v_add_f32_dpp v132, v132, v132 quad_perm:[2,3,0,1] row_mask:0xf bank_mask:0xf
    s_nop 1
    v_add_f32_dpp v132, v132, v132 row_half_mirror row_mask:0xf bank_mask:0xf
    s_nop 1
    v_add_f32_dpp v132, v132, v132 row_mirror row_mask:0xf bank_mask:0xf
    v_mov_b32 v133, v132
    s_nop 1
    v_permlane16_swap_b32 v133, v132
    s_nop 0
    v_add_f32 v132, v132, v133
    v_mul_f32 v132, 0x3acccccd, v132
    v_pk_add_f32 v[140:141], v[108:109], v[132:133] op_sel_hi:[1,0] neg_lo:[0,1] neg_hi:[0,1]
    v_pk_mul_f32 v[136:137], v[140:141], v[140:141]
    v_pk_add_f32 v[140:141], v[110:111], v[132:133] op_sel_hi:[1,0] neg_lo:[0,1] neg_hi:[0,1]
    v_pk_mul_f32 v[138:139], v[140:141], v[140:141]
    v_pk_add_f32 v[140:141], v[112:113], v[132:133] op_sel_hi:[1,0] neg_lo:[0,1] neg_hi:[0,1]
    v_pk_fma_f32 v[136:137], v[140:141], v[140:141], v[136:137]
    v_pk_add_f32 v[140:141], v[114:115], v[132:133] op_sel_hi:[1,0] neg_lo:[0,1] neg_hi:[0,1]
    v_pk_fma_f32 v[138:139], v[140:141], v[140:141], v[138:139]
    v_pk_add_f32 v[140:141], v[116:117], v[132:133] op_sel_hi:[1,0] neg_lo:[0,1] neg_hi:[0,1]
    v_pk_fma_f32 v[136:137], v[140:141], v[140:141], v[136:137]
    v_pk_add_f32 v[140:141], v[118:119], v[132:133] op_sel_hi:[1,0] neg_lo:[0,1] neg_hi:[0,1]
    v_pk_fma_f32 v[138:139], v[140:141], v[140:141], v[138:139]
    v_pk_add_f32 v[140:141], v[120:121], v[132:133] op_sel_hi:[1,0] neg_lo:[0,1] neg_hi:[0,1]
    v_pk_fma_f32 v[136:137], v[140:141], v[140:141], v[136:137]
    v_pk_add_f32 v[140:141], v[122:123], v[132:133] op_sel_hi:[1,0] neg_lo:[0,1] neg_hi:[0,1]
    v_pk_fma_f32 v[138:139], v[140:141], v[140:141], v[138:139]
    v_pk_add_f32 v[140:141], v[124:125], v[132:133] op_sel_hi:[1,0] neg_lo:[0,1] neg_hi:[0,1]
    v_pk_fma_f32 v[136:137], v[140:141], v[140:141], v[136:137]
    v_pk_add_f32 v[140:141], v[126:127], v[132:133] op_sel_hi:[1,0] neg_lo:[0,1] neg_hi:[0,1]
    v_pk_fma_f32 v[138:139], v[140:141], v[140:141], v[138:139]
    v_pk_add_f32 v[136:137], v[136:137], v[138:139]
    v_add_f32 v136, v136, v137
    v_cvt_pk_bf16_f32 v132, v132, v132
    v_and_b32 v132, 0xffff0000, v132
    v_add_f32_dpp v136, v136, v136 quad_perm:[1,0,3,2] row_mask:0xf bank_mask:0xf
    v_pk_add_f32 v[108:109], v[108:109], v[132:133] op_sel_hi:[1,0] neg_lo:[0,1] neg_hi:[0,1]
    v_cvt_pk_bf16_f32 v96, v108, v109
    v_add_f32_dpp v136, v136, v136 quad_perm:[2,3,0,1] row_mask:0xf bank_mask:0xf
    v_lshlrev_b32 v108, 16, v96
    v_and_b32 v109, 0xffff0000, v96
    v_add_f32_dpp v136, v136, v136 row_half_mirror row_mask:0xf bank_mask:0xf
    v_pk_add_f32 v[110:111], v[110:111], v[132:133] op_sel_hi:[1,0] neg_lo:[0,1] neg_hi:[0,1]
    v_cvt_pk_bf16_f32 v97, v110, v111
    v_add_f32_dpp v136, v136, v136 row_mirror row_mask:0xf bank_mask:0xf
    v_lshlrev_b32 v110, 16, v97
    v_and_b32 v111, 0xffff0000, v97
    v_mov_b32 v137, v136
    v_pk_add_f32 v[112:113], v[112:113], v[132:133] op_sel_hi:[1,0] neg_lo:[0,1] neg_hi:[0,1]
    v_cvt_pk_bf16_f32 v98, v112, v113
    v_permlane16_swap_b32 v137, v136
    v_lshlrev_b32 v112, 16, v98
    v_and_b32 v113, 0xffff0000, v98
    v_add_f32 v136, v136, v137
    v_pk_add_f32 v[114:115], v[114:115], v[132:133] op_sel_hi:[1,0] neg_lo:[0,1] neg_hi:[0,1]
    v_cvt_pk_bf16_f32 v99, v114, v115
    v_mul_f32 v136, 0x3acccccd, v136
    v_lshlrev_b32 v114, 16, v99
    v_and_b32 v115, 0xffff0000, v99
    v_cvt_pk_bf16_f32 v136, v136, v136
    v_pk_add_f32 v[116:117], v[116:117], v[132:133] op_sel_hi:[1,0] neg_lo:[0,1] neg_hi:[0,1]
    v_cvt_pk_bf16_f32 v100, v116, v117
    v_and_b32 v136, 0xffff0000, v136
    v_lshlrev_b32 v116, 16, v100
    v_and_b32 v117, 0xffff0000, v100
    v_add_f32 v136, 0x3727c5ac, v136
    v_pk_add_f32 v[118:119], v[118:119], v[132:133] op_sel_hi:[1,0] neg_lo:[0,1] neg_hi:[0,1]
    v_cvt_pk_bf16_f32 v101, v118, v119
    v_cvt_pk_bf16_f32 v136, v136, v136
    v_lshlrev_b32 v118, 16, v101
    v_and_b32 v119, 0xffff0000, v101
    v_and_b32 v136, 0xffff0000, v136
    v_pk_add_f32 v[120:121], v[120:121], v[132:133] op_sel_hi:[1,0] neg_lo:[0,1] neg_hi:[0,1]
    v_cvt_pk_bf16_f32 v102, v120, v121
    v_sqrt_f32 v136, v136
    v_lshlrev_b32 v120, 16, v102
    v_and_b32 v121, 0xffff0000, v102
    v_cvt_pk_bf16_f32 v136, v136, v136
    v_pk_add_f32 v[122:123], v[122:123], v[132:133] op_sel_hi:[1,0] neg_lo:[0,1] neg_hi:[0,1]
    v_cvt_pk_bf16_f32 v103, v122, v123
    v_and_b32 v136, 0xffff0000, v136
    v_lshlrev_b32 v122, 16, v103
    v_and_b32 v123, 0xffff0000, v103
    v_rcp_f32 v136, v136
    v_pk_add_f32 v[124:125], v[124:125], v[132:133] op_sel_hi:[1,0] neg_lo:[0,1] neg_hi:[0,1]
    v_cvt_pk_bf16_f32 v104, v124, v125
    v_lshlrev_b32 v124, 16, v104
    v_and_b32 v125, 0xffff0000, v104
    v_pk_add_f32 v[126:127], v[126:127], v[132:133] op_sel_hi:[1,0] neg_lo:[0,1] neg_hi:[0,1]
    v_cvt_pk_bf16_f32 v105, v126, v127
    v_lshlrev_b32 v126, 16, v105
    v_and_b32 v127, 0xffff0000, v105
    v_pk_mul_f32 v[108:109], v[108:109], v[136:137] op_sel_hi:[1,0]
    v_cvt_pk_bf16_f32 v96, v108, v109
    v_pk_mul_f32 v[110:111], v[110:111], v[136:137] op_sel_hi:[1,0]
    v_cvt_pk_bf16_f32 v97, v110, v111
    ds_write_b64 v128, v[96:97] offset:0
    v_pk_mul_f32 v[112:113], v[112:113], v[136:137] op_sel_hi:[1,0]
    v_cvt_pk_bf16_f32 v98, v112, v113
    v_pk_mul_f32 v[114:115], v[114:115], v[136:137] op_sel_hi:[1,0]
    v_cvt_pk_bf16_f32 v99, v114, v115
    ds_write_b64 v128, v[98:99] offset:2304
    v_pk_mul_f32 v[116:117], v[116:117], v[136:137] op_sel_hi:[1,0]
    v_cvt_pk_bf16_f32 v100, v116, v117
    v_pk_mul_f32 v[118:119], v[118:119], v[136:137] op_sel_hi:[1,0]
    v_cvt_pk_bf16_f32 v101, v118, v119
    ds_write_b64 v128, v[100:101] offset:4608
    v_pk_mul_f32 v[120:121], v[120:121], v[136:137] op_sel_hi:[1,0]
    v_cvt_pk_bf16_f32 v102, v120, v121
    v_pk_mul_f32 v[122:123], v[122:123], v[136:137] op_sel_hi:[1,0]
    v_cvt_pk_bf16_f32 v103, v122, v123
    ds_write_b64 v128, v[102:103] offset:6912
    v_pk_mul_f32 v[124:125], v[124:125], v[136:137] op_sel_hi:[1,0]
    v_cvt_pk_bf16_f32 v104, v124, v125
    v_pk_mul_f32 v[126:127], v[126:127], v[136:137] op_sel_hi:[1,0]
    v_cvt_pk_bf16_f32 v105, v126, v127
    ds_write_b64 v128, v[104:105] offset:9216
    s_waitcnt lgkmcnt(0)
    s_barrier
    ds_read_b128 v[160:163], v130 offset:0
    ds_read_b128 v[164:167], v130 offset:4608
    ds_read_b128 v[168:171], v130 offset:9216
    s_mul_i32 s42, s42, 1664525
    s_add_u32 s42, s42, 1013904223
    v_mov_b32 v20, 0
    v_mov_b32 v21, s42
    s_waitcnt lgkmcnt(2)
    buffer_store_dwordx4 v[160:163], v131, s[8:11], s98 offen sc1
    s_waitcnt lgkmcnt(1)
    buffer_store_dwordx4 v[164:167], v131, s[8:11], s99 offen sc1
    s_waitcnt lgkmcnt(0)
    buffer_store_dwordx4 v[168:171], v131, s[8:11], s100 offen sc1
    s_mul_i32 s0, s56, 4352
    s_and_b32 s50, s38, 3
    s_lshl2_add_u32 s0, s50, s0
    s_add_u32 s0, s0, 8192
    s_mul_i32 s57, s49, 4352
    s_add_u32 s57, s57, 286720
    s_lshl4_add_u32 s1, s47, s57
    s_cmp_eq_u32 s36, 0
    s_cselect_b32 s0, s0, 2146435072
    s_cselect_b32 s1, s1, 2146435072
    v_lshrrev_b32 v80, 4, v0
    v_bfe_u32 v81, v0, 2, 2
    v_and_b32 v82, 3, v0
    v_lshl_add_u32 v83, v80, 3, v81
    v_lshlrev_b32 v83, 7, v83
    v_add_u32 v83, s59, v83
    v_lshl_add_u32 v86, v82, 4, v83
    v_add_u32 v86, 102400, v86
    s_add_u32 s97, s101, 81920
    s_waitcnt vmcnt(4)
    ds_read_b64_tr_b16 v[144:145], v86 offset:0
    ds_read_b64_tr_b16 v[146:147], v86 offset:512
    ds_read_b64_tr_b16 v[148:149], v86 offset:8
    ds_read_b64_tr_b16 v[150:151], v86 offset:520
    ds_read_b64_tr_b16 v[152:153], v86 offset:64
    ds_read_b64_tr_b16 v[154:155], v86 offset:576
    ds_read_b64_tr_b16 v[156:157], v86 offset:72
    ds_read_b64_tr_b16 v[158:159], v86 offset:584
    s_waitcnt lgkmcnt(6)
    buffer_store_dwordx4 v[144:147], v1, s[8:11], s101 offen offset:0 sc1
    s_waitcnt lgkmcnt(4)
    buffer_store_dwordx4 v[148:151], v1, s[8:11], s101 offen offset:1024 sc1
    s_waitcnt lgkmcnt(2)
    buffer_store_dwordx4 v[152:155], v1, s[8:11], s97 offen offset:0 sc1
    s_waitcnt lgkmcnt(0)
    buffer_store_dwordx4 v[156:159], v1, s[8:11], s97 offen offset:1024 sc1
    s_and_b32 s51, s36, 1
    s_lshr_b32 s52, s36, 1
    s_lshl1_add_u32 s51, s51, s52
    s_lshl_b32 s51, s51, 11
    s_add_u32 m0, s51, 151552
    s_nop 0
    buffer_load_dwordx4 v69, s[32:35], s90 offen offset:0 lds
    s_add_u32 s90, s90, 9216
    buffer_load_dwordx4 v69, s[32:35], s90 offen offset:1024 lds
    s_add_u32 s90, s90, 9216
    v_min_u32 v77, 24, v0
    v_lshlrev_b32 v77, 7, v77
    s_mul_i32 s51, s2, 3200
    s_cmp_eq_u32 s36, 2
    s_cselect_b32 s52, s51, 2146435072
    buffer_load_dword v76, v77, s[20:23], s52 offen
    s_cmp_eq_u32 s36, 3
    s_cselect_b32 s52, s51, 2146435072
    buffer_load_dword v88, v77, s[24:27], s52 offen
    v_and_b32 v108, 15, v0
    v_add_u32 v4, 4096, v1
    v_add_u32 v2, 61440, v1
    v_add_u32 v3, 122880, v1
    v_lshrrev_b32 v109, 1, v108
    v_and_b32 v110, 1, v0
    v_and_b32 v111, 6, v109
    v_or_b32 v111, v111, v110
    v_xor_b32 v111, v111, v80
    v_lshlrev_b32 v111, 4, v111
    v_lshl_add_u32 v111, v109, 7, v111
    v_mul_u32_u24 v110, 5120, v110
    v_add_u32 v10, v110, v111
    v_xor_b32 v11, 64, v10
    v_and_b32 v111, 6, v85
    v_xor_b32 v111, v111, v80
    v_lshlrev_b32 v111, 4, v111
    v_lshl_add_u32 v111, v85, 7, v111
    v_bfe_u32 v110, v0, 3, 1
    v_mul_u32_u24 v110, 5120, v110
    v_add_u32 v12, v110, v111
    v_xor_b32 v13, 64, v12
    v_lshl_add_u32 v70, v82, 3, v83
    v_and_b32 v70, 0x1fff, v70
    v_add_u32 v70, 151552, v70
    v_mov_b32 v77, 2146435072
    v_cmp_eq_u32 vcc, 0, v0
    v_lshlrev_b32 v78, 3, v0
    s_nop 0
    v_cndmask_b32 v18, v77, v0, vcc
    v_cmp_gt_u32 vcc, 20, v0
    s_nop 1
    v_cndmask_b32 v63, v77, v78, vcc
    s_lshl_b32 s58, s38, 5
    s_add_u32 s58, s58, s37
    s_lshl2_add_u32 s58, s58, s36
    s_mul_i32 s58, s58, 160
    s_add_u32 s58, s58, 1703936
    v_mul_u32_u24 v110, 80, v108
    v_add_u32 v51, 143360, v110
    v_lshl_add_u32 v110, v80, 2, v110
    s_lshl_b32 s51, s36, 4
    s_add_u32 s51, s51, 143372
    v_add_u32 v48, s51, v110
    s_add_u32 s51, s45, 143360
    v_lshlrev_b32 v110, 5, v108
    v_xor_b32 v111, v80, v81
    v_lshl_add_u32 v110, v111, 3, v110
    v_add_u32 v64, s51, v110
    v_lshrrev_b32 v110, 1, v80
    v_and_b32 v111, 1, v80
    v_mul_u32_u24 v112, 2560, v110
    v_lshl_add_u32 v112, v111, 5, v112
    v_lshl_add_u32 v112, v81, 6, v112
    v_lshrrev_b32 v113, 1, v81
    v_xor_b32 v113, v113, v82
    v_lshl_add_u32 v112, v113, 3, v112
    v_add_u32 v65, s51, v112
    v_xor_b32 v66, 16, v65
    v_mul_u32_u24 v112, 90112, v110
    v_mul_u32_u24 v111, 20480, v111
    v_add_u32 v112, v112, v111
    v_lshl_add_u32 v67, v108, 4, v112
    v_lshlrev_b32 v68, 2, v108
    s_and_b32 s51, s2, 1
    s_lshl_b32 s51, s51, 3
    s_and_b32 s52, s2, 2
    s_lshl_b32 s52, s52, 1
    s_add_u32 s39, s51, s52
    s_bfe_u32 s51, s2, 131075
    s_add_u32 s39, s39, s51
    s_lshr_b32 s40, s2, 5
    s_bfe_u32 s41, s2, 65538
    s_and_b32 s51, s2, 0
    s_add_u32 s40, s40, s51
    s_mul_i32 s44, s38, 245760
    s_add_u32 s44, s44, s45
    s_add_u32 s44, s44, 4718592
    s_mul_i32 s48, s40, 245760
    s_add_u32 s48, s48, s45
    s_add_u32 s48, s48, 8650752
    s_mul_i32 s49, s40, 102400
    s_and_b32 s51, s36, 1
    s_mul_i32 s51, s51, 10240
    s_add_u32 s49, s49, s51
    s_lshr_b32 s51, s36, 1
    s_lshl_b32 s51, s51, 7
    s_add_u32 s49, s49, s51
    s_lshl_b32 s51, s39, 2
    s_add_u32 s51, s51, s36
    s_lshl_b32 s52, s51, 1
    s_add_u32 s52, s52, s41
    s_mul_i32 s47, s52, 90112
    s_add_u32 s47, s47, 10616832
    s_xor_b32 s52, s52, 1
    s_mul_i32 s59, s52, 90112
    s_add_u32 s59, s59, 10616832
    s_mul_i32 s95, s39, 4352
    s_add_u32 s95, s95, 325888
    s_lshl2_add_u32 s51, s37, s36
    s_mul_i32 s43, s51, 40960
    s_add_u32 s43, s43, 2097152
    s_mul_i32 s46, s51, 180224
    s_add_u32 s46, s46, 10616832
    s_mul_i32 s51, s51, 4352
    s_add_u32 s3, s51, 8192
    s_mul_i32 s51, s37, 4352
    s_lshl2_add_u32 s56, s38, s51
    s_add_u32 s56, s56, 325888
    s_cmp_eq_u32 s36, 0
    s_cselect_b32 s56, s56, 2146435072
    s_mul_i32 s53, s91, 86
    s_lshr_b32 s53, s53, 8
    s_mul_i32 s54, s53, 3
    s_sub_u32 s54, s91, s54
    s_lshl4_add_u32 s54, s54, s53
    s_mul_i32 s54, s54, 5120
    s_add_u32 s54, s54, 8650752
    s_cmp_lt_u32 s2, 240
    s_cselect_b32 s54, s54, 2146435072
    s_and_b32 s53, s36, 2
    s_lshl2_add_u32 s55, s92, s53
    s_lshl_b32 s53, s53, 5
    v_add_u32 v70, s53, v70
    s_add_u32 s51, s55, 0
    s_mul_i32 s52, s51, 52
    s_lshr_b32 s52, s52, 8
    s_mul_i32 s52, s52, 235
    s_add_u32 s51, s51, s52
    s_lshl_b32 s51, s51, 10
    s_add_u32 s91, s51, s54
    s_add_u32 s51, s55, 1
    s_mul_i32 s52, s51, 52
    s_lshr_b32 s52, s52, 8
    s_mul_i32 s52, s52, 235
    s_add_u32 s51, s51, s52
    s_lshl_b32 s51, s51, 10
    s_add_u32 s92, s51, s54
    s_waitcnt vmcnt(8)
    s_barrier
    buffer_store_dword v21, v18, s[8:11], s0 offen sc1
    v_add_u32 v63, 10240, v63
    v_subrev_u32 v77, 20, v0
    s_cmp_eq_u32 s37, 0
    s_cselect_b32 s51, 0, 20
    v_cmp_gt_u32 vcc, s51, v77
    v_lshlrev_b32 v77, 3, v77
    s_nop 0
    v_cndmask_b32 v63, v63, v77, vcc
    s_add_u32 m0, s45, 0
    s_add_u32 s96, s61, 0
    buffer_load_dwordx4 v5, s[16:19], s96 offen lds
    buffer_load_dwordx4 v6, s[16:19], s96 offen offset:1024 lds
    buffer_load_dwordx4 v7, s[16:19], s96 offen offset:2048 lds
    buffer_load_dwordx4 v8, s[16:19], s96 offen offset:3072 lds
    v_lshlrev_b32 v117, 16, v209
    v_lshlrev_b32 v118, 16, v210
    v_lshlrev_b32 v119, 16, v211
    v_mul_f32 v119, 0x3fb8aa3b, v119
    v_exp_f32 v119, v119
    v_mul_f32 v134, v117, v117
    v_cvt_pk_bf16_f32 v119, v119, v119
    v_and_b32 v119, 0xffff0000, v119
    v_mul_f32 v132, v119, v117
    v_mul_f32 v133, v119, v118
    v_mul_f32 v132, 0x3fb8aa3b, v132
    v_mul_f32 v133, 0.15915494309189535, v133
    v_exp_f32 v132, v132
    v_fract_f32 v133, v133
    v_fmac_f32 v134, v118, v118
    v_cos_f32 v120, v133
    v_sin_f32 v121, v133
    v_rcp_f32 v134, v134
    v_mul_f32 v120, v120, v132
    v_mul_f32 v121, v121, v132
    v_add_f32 v134, v134, v134
    v_add_f32 v135, -1.0, v120
    v_mul_f32 v122, v135, v117
    v_fmac_f32 v122, v121, v118
    v_mul_f32 v123, v121, v117
    v_fma_f32 v123, -v135, v118, v123
    v_mul_f32 v122, v122, v134
    v_mul_f32 v123, v123, v134
    v_mul_f32 v136, v121, v121
    v_add_f32 v137, v120, v120
    v_fma_f32 v124, v120, v120, -v136
    v_mul_f32 v125, v137, v121
    v_mul_f32 v136, v125, v125
    v_add_f32 v137, v124, v124
    v_fma_f32 v124, v124, v124, -v136
    v_mul_f32 v125, v137, v125
    v_mul_f32 v136, v125, v125
    v_add_f32 v137, v124, v124
    v_fma_f32 v124, v124, v124, -v136
    v_mul_f32 v125, v137, v125
    v_mul_f32 v136, v125, v125
    v_add_f32 v137, v124, v124
    v_fma_f32 v126, v124, v124, -v136
    v_mul_f32 v127, v137, v125
    v_mul_f32 v136, v127, v127
    v_add_f32 v137, v126, v126
    v_fma_f32 v126, v126, v126, -v136
    v_mul_f32 v127, v137, v127
    v_mul_f32 v174, v122, v126
    v_mul_f32 v175, v122, v127
    v_fma_f32 v174, -v123, v127, v174
    v_fmac_f32 v175, v123, v126
    s_bitcmp1_b32 s36, 0
    s_cselect_b64 s[100:101], -1, 0
    v_cndmask_b32 v176, v122, v174, s[100:101]
    v_cndmask_b32 v177, v123, v175, s[100:101]
    v_mul_f32 v136, v127, v127
    v_add_f32 v137, v126, v126
    v_fma_f32 v126, v126, v126, -v136
    v_mul_f32 v127, v137, v127
    v_mul_f32 v174, v176, v126
    v_mul_f32 v175, v176, v127
    v_fma_f32 v174, -v177, v127, v174
    v_fmac_f32 v175, v177, v126
    s_bitcmp1_b32 s36, 1
    s_cselect_b64 s[100:101], -1, 0
    v_cndmask_b32 v172, v176, v174, s[100:101]
    v_cndmask_b32 v173, v177, v175, s[100:101]
    v_mul_f32 v136, v127, v127
    v_add_f32 v137, v126, v126
    v_fma_f32 v126, v126, v126, -v136
    v_mul_f32 v127, v137, v127
    v_mul_f32 v174, v172, v124
    v_mul_f32 v175, v172, v125
    v_fma_f32 v174, -v173, v125, v174
    v_fmac_f32 v175, v173, v124
    v_mul_f32 v176, v174, v124
    v_mul_f32 v177, v174, v125
    v_fma_f32 v176, -v175, v125, v176
    v_fmac_f32 v177, v175, v124
    v_mul_f32 v178, v176, v124
    v_mul_f32 v179, v176, v125
    v_fma_f32 v178, -v177, v125, v178
    v_fmac_f32 v179, v177, v124
    v_mul_f32 v136, v127, v127
    v_add_f32 v137, v126, v126
    v_fma_f32 v128, v126, v126, -v136
    v_mul_f32 v129, v137, v127
    v_mul_f32 v136, v129, v129
    v_add_f32 v137, v128, v128
    v_fma_f32 v128, v128, v128, -v136
    v_mul_f32 v129, v137, v129
    v_mul_f32 v136, v128, v126
    v_mul_f32 v137, v128, v127
    v_fma_f32 v136, -v129, v127, v136
    v_fma_f32 v129, v129, v126, v137
    v_mov_b32 v128, v136
    v_mul_f32 v136, v129, v129
    v_add_f32 v137, v128, v128
    v_fma_f32 v130, v128, v128, -v136
    v_mul_f32 v131, v137, v129
    s_mul_i32 s98, s36, 1920
    s_add_u32 s98, s98, 143360
    v_min_u32 v132, 39, v0
    v_mul_u32_u24 v132, 48, v132
    v_add_u32 v132, s98, v132
    ds_write_b128 v132, v[120:123]
    ds_write_b128 v132, v[124:127] offset:16
    ds_write_b128 v132, v[128:131] offset:32
    v_bfe_u32 v133, v0, 1, 3
    v_mul_u32_u24 v133, 48, v133
    v_add_u32 v133, s98, v133
    v_mul_u32_u24 v134, 205, v0
    v_lshrrev_b32 v134, 12, v134
    v_mul_u32_u24 v135, 20, v134
    v_sub_u32 v135, v0, v135
    v_min_u32 v134, 2, v134
    s_mul_i32 s99, s36, 20
    v_add_u32 v138, s99, v135
    v_lshrrev_b32 v139, 1, v138
    v_mul_u32_u24 v139, 48, v139
    v_add_u32 v139, s98, v139
    ds_read_b128 v[140:143], v133 offset:0
    ds_read_b128 v[144:147], v133 offset:384
    ds_read_b128 v[148:151], v133 offset:768
    ds_read_b128 v[152:155], v133 offset:1152
    ds_read_b128 v[156:159], v133 offset:1536
    ds_read_b128 v[160:163], v139 offset:16
    ds_read_b128 v[164:167], v139 offset:32
    ds_write_b128 v132, v[172:175]
    ds_write_b128 v132, v[176:179] offset:16
    v_lshrrev_b32 v170, 4, v0
    v_lshl_add_u32 v133, v170, 3, v133
    ds_read_b64 v[120:121], v133 offset:0
    ds_read_b64 v[122:123], v133 offset:384
    ds_read_b64 v[124:125], v133 offset:768
    ds_read_b64 v[126:127], v133 offset:1152
    ds_read_b64 v[128:129], v133 offset:1536
    v_lshlrev_b32 v136, 31, v0
    v_xor_b32 v137, 0x80000000, v136
    v_mul_u32_u24 v49, 80, v138
    v_add_u32 v49, 143360, v49
    v_mul_u32_u24 v169, 3200, v134
    v_lshl_add_u32 v50, v134, 2, v49
    v_lshl_add_u32 v62, v135, 3, v169
    s_waitcnt lgkmcnt(13)
    v_mov_b32 v22, v140
    v_xor_b32 v27, v137, v141
    v_xor_b32 v32, v136, v142
    v_xor_b32 v37, 0x80000000, v143
    s_waitcnt lgkmcnt(4)
    v_xor_b32 v52, v136, v120
    v_xor_b32 v57, 0x80000000, v121
    v_mov_b32 v23, v144
    v_xor_b32 v28, v137, v145
    v_xor_b32 v33, v136, v146
    v_xor_b32 v38, 0x80000000, v147
    s_waitcnt lgkmcnt(3)
    v_xor_b32 v53, v136, v122
    v_xor_b32 v58, 0x80000000, v123
    v_mov_b32 v24, v148
    v_xor_b32 v29, v137, v149
    v_xor_b32 v34, v136, v150
    v_xor_b32 v39, 0x80000000, v151
    s_waitcnt lgkmcnt(2)
    v_xor_b32 v54, v136, v124
    v_xor_b32 v59, 0x80000000, v125
    v_mov_b32 v25, v152
    v_xor_b32 v30, v137, v153
    v_xor_b32 v35, v136, v154
    v_xor_b32 v40, 0x80000000, v155
    s_waitcnt lgkmcnt(1)
    v_xor_b32 v55, v136, v126
    v_xor_b32 v60, 0x80000000, v127
    v_mov_b32 v26, v156
    v_xor_b32 v31, v137, v157
    v_xor_b32 v36, v136, v158
    v_xor_b32 v41, 0x80000000, v159
    s_waitcnt lgkmcnt(0)
    v_xor_b32 v56, v136, v128
    v_xor_b32 v61, 0x80000000, v129
    v_cmp_eq_u32 s[100:101], 0, v134
    v_mov_b32 v42, v160
    v_xor_b32 v43, v137, v161
    v_mov_b32 v44, v162
    v_cndmask_b32 v164, v164, v166, s[100:101]
    v_cndmask_b32 v165, v165, v167, s[100:101]
    v_cmp_ne_u32 s[100:101], 2, v134
    v_xor_b32 v45, v137, v163
    v_xor_b32 v165, v137, v165
    v_cndmask_b32 v46, 1.0, v164, s[100:101]
    v_cndmask_b32 v47, 0, v165, s[100:101]
    s_add_u32 m0, s45, 4096
    s_nop 0
    buffer_load_dwordx4 v9, s[16:19], s96 offen lds
    s_add_u32 m0, s45, 20480
    s_add_u32 s96, s61, 256
    buffer_load_dwordx4 v5, s[16:19], s96 offen lds
    buffer_load_dwordx4 v6, s[16:19], s96 offen offset:1024 lds
    buffer_load_dwordx4 v7, s[16:19], s96 offen offset:2048 lds
    buffer_load_dwordx4 v8, s[16:19], s96 offen offset:3072 lds
    s_add_u32 m0, s45, 24576
    s_nop 0
    buffer_load_dwordx4 v9, s[16:19], s96 offen lds
    v_lshlrev_b32 v78, 2, v82
    buffer_load_dword v79, v78, s[8:11], s3 offen offset:0 sc1
    s_add_u32 m0, s45, 40960
    s_add_u32 s96, s61, 512
    buffer_load_dwordx4 v5, s[16:19], s96 offen lds
    buffer_load_dwordx4 v6, s[16:19], s96 offen offset:1024 lds
    buffer_load_dwordx4 v7, s[16:19], s96 offen offset:2048 lds
    buffer_load_dwordx4 v8, s[16:19], s96 offen offset:3072 lds
L_pad0:
    s_cbranch_execz L_pad4
    s_add_u32 m0, s45, 45056
    s_nop 0
    buffer_load_dwordx4 v9, s[16:19], s96 offen lds
    s_mov_b64 exec, 0
    s_cmp_eq_u32 s36, 0
    s_cbranch_scc1 L_pad0
    s_cmp_eq_u32 s36, 1
    s_cbranch_scc1 L_pad1
    s_cmp_eq_u32 s36, 2
    s_cbranch_scc1 L_pad2
    s_branch L_pad3
L_back:
    s_mov_b64 exec, -1
    s_waitcnt vmcnt(5)
    v_cmp_ne_u32 vcc, s42, v79
    s_cbranch_vccnz L_slow0
L_ok0:
    s_add_u32 s97, s43, 0
    buffer_load_dwordx4 a[0:3], v1, s[8:11], s97 offen offset:0 sc1
    buffer_load_dwordx4 a[4:7], v1, s[8:11], s97 offen offset:1024 sc1
    buffer_load_dwordx4 a[8:11], v1, s[8:11], s97 offen offset:2048 sc1
    buffer_load_dwordx4 a[12:15], v1, s[8:11], s97 offen offset:3072 sc1
    s_add_u32 s97, s43, 4096
    buffer_load_dwordx4 a[16:19], v1, s[8:11], s97 offen offset:0 sc1
    buffer_load_dwordx4 a[20:23], v1, s[8:11], s97 offen offset:1024 sc1
    buffer_load_dwordx4 a[24:27], v1, s[8:11], s97 offen offset:2048 sc1
    buffer_load_dwordx4 a[28:31], v1, s[8:11], s97 offen offset:3072 sc1
    s_add_u32 s97, s43, 8192
    buffer_load_dwordx4 a[32:35], v1, s[8:11], s97 offen offset:0 sc1
    s_barrier
    ds_read_b128 a[160:163], v10 offset:0
    ds_read_b128 a[164:167], v11 offset:0
    ds_read_b128 a[168:171], v10 offset:1024
    ds_read_b128 a[172:175], v11 offset:1024
    ds_read_b128 a[176:179], v10 offset:2048
    ds_read_b128 a[180:183], v11 offset:2048
    ds_read_b128 a[184:187], v10 offset:3072
    buffer_store_dword v21, v18, s[8:11], s1 offen sc1
    v_lshrrev_b32 v71, 2, v0
    v_and_b32 v72, 12, v71
    v_add_u32 v71, v71, v72
    v_mul_u32_u24 v71, 1280, v71
    v_and_b32 v72, 3, v0
    v_lshl_add_u32 v69, v72, 3, v71
    v_lshrrev_b32 v71, 5, v0
    v_lshlrev_b32 v71, 8, v71
    v_lshl_add_u32 v71, v68, 2, v71
    v_bfe_u32 v72, v0, 4, 1
    v_lshl_add_u32 v73, v72, 3, v71
    s_lshl2_add_u32 s98, s39, s36
    s_lshl3_add_u32 s99, s98, s41
    s_lshl_b32 s99, s99, 5
    s_add_u32 s99, s99, s40
    s_mul_i32 s99, s99, 160
    s_mul_i32 s98, s98, 40
    s_add_u32 s98, s98, s41
    s_mul_i32 s100, s40, 5
    s_add_u32 s98, s98, s100
    s_and_b32 s100, s40, 1
    s_lshl_b32 s98, s98, 1
    s_sub_u32 s98, s98, s100
    s_lshl_b32 s98, s98, 9
    s_add_u32 s98, s98, 2097152
    s_lshl_b32 s100, s100, 10
    s_add_u32 s100, s100, s98
    s_add_u32 s101, s98, 4096
    buffer_load_dwordx4 a[36:39], v1, s[8:11], s97 offen offset:1024 sc1
    buffer_load_dwordx4 a[40:43], v1, s[8:11], s97 offen offset:2048 sc1
    buffer_load_dwordx4 a[44:47], v1, s[8:11], s97 offen offset:3072 sc1
    s_waitcnt vmcnt(12) lgkmcnt(5)
    v_mfma_f32_16x16x32_bf16 v[76:79], a[0:3], a[160:163], 0
    ds_read_b128 a[188:191], v11 offset:3072
    s_add_u32 s97, s43, 12288
    buffer_load_dwordx4 a[48:51], v1, s[8:11], s97 offen offset:0 sc1
    buffer_load_dwordx4 a[52:55], v1, s[8:11], s97 offen offset:1024 sc1
    s_waitcnt vmcnt(12)
    v_mfma_f32_16x16x32_bf16 v[76:79], a[8:11], a[164:167], v[76:79]
    v_mfma_f32_16x16x32_bf16 v[80:83], a[4:7], a[160:163], 0
    buffer_load_dwordx4 a[56:59], v1, s[8:11], s97 offen offset:2048 sc1
    s_waitcnt vmcnt(12)
    v_mfma_f32_16x16x32_bf16 v[80:83], a[12:15], a[164:167], v[80:83]
    ds_read_b128 a[192:195], v10 offset:4096
    s_waitcnt lgkmcnt(5)
    v_mfma_f32_16x16x32_bf16 v[84:87], a[0:3], a[168:171], 0
    ds_read_b128 a[196:199], v11 offset:4096
    v_mfma_f32_16x16x32_bf16 v[84:87], a[8:11], a[172:175], v[84:87]
    v_mfma_f32_16x16x32_bf16 v[88:91], a[4:7], a[168:171], 0
    v_mfma_f32_16x16x32_bf16 v[88:91], a[12:15], a[172:175], v[88:91]
    ds_read_b128 a[160:163], v10 offset:10240
    s_waitcnt lgkmcnt(5)
    v_mfma_f32_16x16x32_bf16 v[92:95], a[0:3], a[176:179], 0
    ds_read_b128 a[164:167], v11 offset:10240
    buffer_load_dwordx4 a[60:63], v1, s[8:11], s97 offen offset:3072 sc1
    v_mfma_f32_16x16x32_bf16 v[92:95], a[8:11], a[180:183], v[92:95]
    v_mfma_f32_16x16x32_bf16 v[96:99], a[4:7], a[176:179], 0
    v_mfma_f32_16x16x32_bf16 v[96:99], a[12:15], a[180:183], v[96:99]
    ds_read_b128 a[168:171], v10 offset:11264
    s_waitcnt lgkmcnt(5)
    v_mfma_f32_16x16x32_bf16 v[100:103], a[0:3], a[184:187], 0
    ds_read_b128 a[172:175], v11 offset:11264
    s_add_u32 s97, s43, 16384
    v_mfma_f32_16x16x32_bf16 v[100:103], a[8:11], a[188:191], v[100:103]
    buffer_load_dwordx4 a[64:67], v1, s[8:11], s97 offen offset:0 sc1
    v_mfma_f32_16x16x32_bf16 v[104:107], a[4:7], a[184:187], 0
    v_mfma_f32_16x16x32_bf16 v[104:107], a[12:15], a[188:191], v[104:107]
    ds_read_b128 a[176:179], v10 offset:12288
    s_waitcnt lgkmcnt(5)
    v_mfma_f32_16x16x32_bf16 v[108:111], a[0:3], a[192:195], 0
    ds_read_b128 a[180:183], v11 offset:12288
    buffer_load_dwordx4 a[68:71], v1, s[8:11], s97 offen offset:1024 sc1
    v_mfma_f32_16x16x32_bf16 v[108:111], a[8:11], a[196:199], v[108:111]
    v_mfma_f32_16x16x32_bf16 v[112:115], a[4:7], a[192:195], 0
    v_mfma_f32_16x16x32_bf16 v[112:115], a[12:15], a[196:199], v[112:115]
    ds_read_b128 a[184:187], v10 offset:13312
    s_waitcnt vmcnt(14) lgkmcnt(5)
    v_mfma_f32_16x16x32_bf16 v[76:79], a[16:19], a[160:163], v[76:79]
    ds_read_b128 a[188:191], v11 offset:13312
    s_waitcnt vmcnt(12)
    v_mfma_f32_16x16x32_bf16 v[76:79], a[24:27], a[164:167], v[76:79]
    v_mfma_f32_16x16x32_bf16 v[80:83], a[20:23], a[160:163], v[80:83]
    buffer_load_dwordx4 a[72:75], v1, s[8:11], s97 offen offset:2048 sc1
    s_waitcnt vmcnt(12)
    v_mfma_f32_16x16x32_bf16 v[80:83], a[28:31], a[164:167], v[80:83]
    ds_read_b128 a[192:195], v10 offset:14336
    s_waitcnt lgkmcnt(5)
    v_mfma_f32_16x16x32_bf16 v[84:87], a[16:19], a[168:171], v[84:87]
    ds_read_b128 a[196:199], v11 offset:14336
    v_mfma_f32_16x16x32_bf16 v[84:87], a[24:27], a[172:175], v[84:87]
    v_mfma_f32_16x16x32_bf16 v[88:91], a[20:23], a[168:171], v[88:91]
    v_mfma_f32_16x16x32_bf16 v[88:91], a[28:31], a[172:175], v[88:91]
    s_barrier
    ds_read_b128 a[160:163], v10 offset:20480
    s_waitcnt lgkmcnt(5)
    v_mfma_f32_16x16x32_bf16 v[92:95], a[16:19], a[176:179], v[92:95]
    ds_read_b128 a[164:167], v11 offset:20480
    buffer_load_dwordx4 a[76:79], v1, s[8:11], s97 offen offset:3072 sc1
    v_mfma_f32_16x16x32_bf16 v[92:95], a[24:27], a[180:183], v[92:95]
    v_mfma_f32_16x16x32_bf16 v[96:99], a[20:23], a[176:179], v[96:99]
    s_add_u32 s97, s43, 20480
    v_mfma_f32_16x16x32_bf16 v[96:99], a[28:31], a[180:183], v[96:99]
    ds_read_b128 a[168:171], v10 offset:21504
    s_waitcnt lgkmcnt(5)
    v_mfma_f32_16x16x32_bf16 v[100:103], a[16:19], a[184:187], v[100:103]
    ds_read_b128 a[172:175], v11 offset:21504
    buffer_load_dwordx4 a[80:83], v1, s[8:11], s97 offen offset:0 sc1
    v_mfma_f32_16x16x32_bf16 v[100:103], a[24:27], a[188:191], v[100:103]
    v_mfma_f32_16x16x32_bf16 v[104:107], a[20:23], a[184:187], v[104:107]
    v_mfma_f32_16x16x32_bf16 v[104:107], a[28:31], a[188:191], v[104:107]
    ds_read_b128 a[176:179], v10 offset:22528
    s_waitcnt lgkmcnt(5)
    v_mfma_f32_16x16x32_bf16 v[108:111], a[16:19], a[192:195], v[108:111]
    ds_read_b128 a[180:183], v11 offset:22528
    buffer_load_dwordx4 a[84:87], v1, s[8:11], s97 offen offset:1024 sc1
    v_mfma_f32_16x16x32_bf16 v[108:111], a[24:27], a[196:199], v[108:111]
    v_mfma_f32_16x16x32_bf16 v[112:115], a[20:23], a[192:195], v[112:115]
    v_mfma_f32_16x16x32_bf16 v[112:115], a[28:31], a[196:199], v[112:115]
    ds_read_b128 a[184:187], v10 offset:23552
    s_waitcnt vmcnt(14) lgkmcnt(5)
    v_mfma_f32_16x16x32_bf16 v[76:79], a[32:35], a[160:163], v[76:79]
    ds_read_b128 a[188:191], v11 offset:23552
    s_waitcnt vmcnt(11)
    v_mfma_f32_16x16x32_bf16 v[76:79], a[40:43], a[164:167], v[76:79]
    buffer_load_dwordx4 a[88:91], v1, s[8:11], s97 offen offset:2048 sc1
    v_mfma_f32_16x16x32_bf16 v[80:83], a[36:39], a[160:163], v[80:83]
    s_waitcnt vmcnt(11)
    v_mfma_f32_16x16x32_bf16 v[80:83], a[44:47], a[164:167], v[80:83]
    ds_read_b128 a[192:195], v10 offset:24576
    s_waitcnt lgkmcnt(5)
    v_mfma_f32_16x16x32_bf16 v[84:87], a[32:35], a[168:171], v[84:87]
    ds_read_b128 a[196:199], v11 offset:24576
    buffer_load_dwordx4 a[92:95], v1, s[8:11], s97 offen offset:3072 sc1
    v_mfma_f32_16x16x32_bf16 v[84:87], a[40:43], a[172:175], v[84:87]
    v_mfma_f32_16x16x32_bf16 v[88:91], a[36:39], a[168:171], v[88:91]
    v_mfma_f32_16x16x32_bf16 v[88:91], a[44:47], a[172:175], v[88:91]
    ds_read_b128 a[160:163], v10 offset:30720
    s_waitcnt lgkmcnt(5)
    v_mfma_f32_16x16x32_bf16 v[92:95], a[32:35], a[176:179], v[92:95]
    ds_read_b128 a[164:167], v11 offset:30720
    s_add_u32 m0, s45, 61440
    v_mfma_f32_16x16x32_bf16 v[92:95], a[40:43], a[180:183], v[92:95]
    s_add_u32 s96, s61, 768
    buffer_load_dwordx4 v5, s[16:19], s96 offen lds
    v_mfma_f32_16x16x32_bf16 v[96:99], a[36:39], a[176:179], v[96:99]
    v_mfma_f32_16x16x32_bf16 v[96:99], a[44:47], a[180:183], v[96:99]
    ds_read_b128 a[168:171], v10 offset:31744
    s_waitcnt lgkmcnt(5)
    v_mfma_f32_16x16x32_bf16 v[100:103], a[32:35], a[184:187], v[100:103]
    ds_read_b128 a[172:175], v11 offset:31744
    v_mfma_f32_16x16x32_bf16 v[100:103], a[40:43], a[188:191], v[100:103]
    buffer_load_dwordx4 v6, s[16:19], s96 offen offset:1024 lds
    v_mfma_f32_16x16x32_bf16 v[104:107], a[36:39], a[184:187], v[104:107]
    v_mfma_f32_16x16x32_bf16 v[104:107], a[44:47], a[188:191], v[104:107]
    ds_read_b128 a[176:179], v10 offset:32768
    s_waitcnt lgkmcnt(5)
    v_mfma_f32_16x16x32_bf16 v[108:111], a[32:35], a[192:195], v[108:111]
    ds_read_b128 a[180:183], v11 offset:32768
    v_mfma_f32_16x16x32_bf16 v[108:111], a[40:43], a[196:199], v[108:111]
    v_mfma_f32_16x16x32_bf16 v[112:115], a[36:39], a[192:195], v[112:115]
    buffer_load_dwordx4 v7, s[16:19], s96 offen offset:2048 lds
    v_mfma_f32_16x16x32_bf16 v[112:115], a[44:47], a[196:199], v[112:115]
    ds_read_b128 a[184:187], v10 offset:33792
    s_waitcnt vmcnt(14) lgkmcnt(5)
    v_mfma_f32_16x16x32_bf16 v[76:79], a[48:51], a[160:163], v[76:79]
    ds_read_b128 a[188:191], v11 offset:33792
    s_waitcnt vmcnt(12)
    v_mfma_f32_16x16x32_bf16 v[76:79], a[56:59], a[164:167], v[76:79]
    v_mfma_f32_16x16x32_bf16 v[80:83], a[52:55], a[160:163], v[80:83]
    buffer_load_dwordx4 v8, s[16:19], s96 offen offset:3072 lds
    s_waitcnt vmcnt(12)
    v_mfma_f32_16x16x32_bf16 v[80:83], a[60:63], a[164:167], v[80:83]
    ds_read_b128 a[192:195], v10 offset:34816
    s_waitcnt lgkmcnt(5)
    v_mfma_f32_16x16x32_bf16 v[84:87], a[48:51], a[168:171], v[84:87]
    ds_read_b128 a[196:199], v11 offset:34816
    v_mfma_f32_16x16x32_bf16 v[84:87], a[56:59], a[172:175], v[84:87]
    v_mfma_f32_16x16x32_bf16 v[88:91], a[52:55], a[168:171], v[88:91]
    v_mfma_f32_16x16x32_bf16 v[88:91], a[60:63], a[172:175], v[88:91]
    s_barrier
    ds_read_b128 a[160:163], v10 offset:40960
    s_waitcnt lgkmcnt(5)
    v_mfma_f32_16x16x32_bf16 v[92:95], a[48:51], a[176:179], v[92:95]
    ds_read_b128 a[164:167], v11 offset:40960
    s_add_u32 m0, s45, 65536
    v_mfma_f32_16x16x32_bf16 v[92:95], a[56:59], a[180:183], v[92:95]
    buffer_load_dwordx4 v9, s[16:19], s96 offen lds
    v_mfma_f32_16x16x32_bf16 v[96:99], a[52:55], a[176:179], v[96:99]
    v_mfma_f32_16x16x32_bf16 v[96:99], a[60:63], a[180:183], v[96:99]
    ds_read_b128 a[168:171], v10 offset:41984
    s_waitcnt lgkmcnt(5)
    v_mfma_f32_16x16x32_bf16 v[100:103], a[48:51], a[184:187], v[100:103]
    ds_read_b128 a[172:175], v11 offset:41984
    v_mfma_f32_16x16x32_bf16 v[100:103], a[56:59], a[188:191], v[100:103]
    s_add_u32 s97, s43, 24576
    buffer_load_dwordx4 a[96:99], v1, s[8:11], s97 offen offset:0 sc1
    v_mfma_f32_16x16x32_bf16 v[104:107], a[52:55], a[184:187], v[104:107]
    v_and_b32 v213, 0x1f0, v1
    v_mfma_f32_16x16x32_bf16 v[104:107], a[60:63], a[188:191], v[104:107]
    ds_read_b128 a[176:179], v10 offset:43008
    s_waitcnt lgkmcnt(5)
    v_mfma_f32_16x16x32_bf16 v[108:111], a[48:51], a[192:195], v[108:111]
    ds_read_b128 a[180:183], v11 offset:43008
    v_mfma_f32_16x16x32_bf16 v[108:111], a[56:59], a[196:199], v[108:111]
    buffer_load_dword v212, v213, s[8:11], s57 offen offset:0 sc1
    buffer_load_dwordx4 a[100:103], v1, s[8:11], s97 offen offset:1024 sc1
    v_mfma_f32_16x16x32_bf16 v[112:115], a[52:55], a[192:195], v[112:115]
    v_mfma_f32_16x16x32_bf16 v[112:115], a[60:63], a[196:199], v[112:115]
    ds_read_b128 a[184:187], v10 offset:44032
    s_waitcnt vmcnt(15) lgkmcnt(5)
    v_mfma_f32_16x16x32_bf16 v[76:79], a[64:67], a[160:163], v[76:79]
    ds_read_b128 a[188:191], v11 offset:44032
    s_waitcnt vmcnt(13)
    v_mfma_f32_16x16x32_bf16 v[76:79], a[72:75], a[164:167], v[76:79]
    v_mfma_f32_16x16x32_bf16 v[80:83], a[68:71], a[160:163], v[80:83]
    buffer_load_dwordx4 a[104:107], v1, s[8:11], s97 offen offset:2048 sc1
    s_waitcnt vmcnt(13)
    v_mfma_f32_16x16x32_bf16 v[80:83], a[76:79], a[164:167], v[80:83]
    ds_read_b128 a[192:195], v10 offset:45056
    s_waitcnt lgkmcnt(5)
    v_mfma_f32_16x16x32_bf16 v[84:87], a[64:67], a[168:171], v[84:87]
    ds_read_b128 a[196:199], v11 offset:45056
    v_mfma_f32_16x16x32_bf16 v[84:87], a[72:75], a[172:175], v[84:87]
    v_mfma_f32_16x16x32_bf16 v[88:91], a[68:71], a[168:171], v[88:91]
    v_mfma_f32_16x16x32_bf16 v[88:91], a[76:79], a[172:175], v[88:91]
    ds_read_b128 a[160:163], v10 offset:51200
    s_waitcnt lgkmcnt(5)
    v_mfma_f32_16x16x32_bf16 v[92:95], a[64:67], a[176:179], v[92:95]
    ds_read_b128 a[164:167], v11 offset:51200
    buffer_load_dwordx4 a[108:111], v1, s[8:11], s97 offen offset:3072 sc1
    v_mfma_f32_16x16x32_bf16 v[92:95], a[72:75], a[180:183], v[92:95]
    v_mfma_f32_16x16x32_bf16 v[96:99], a[68:71], a[176:179], v[96:99]
    v_mfma_f32_16x16x32_bf16 v[96:99], a[76:79], a[180:183], v[96:99]
    ds_read_b128 a[168:171], v10 offset:52224
    s_waitcnt lgkmcnt(5)
    v_mfma_f32_16x16x32_bf16 v[100:103], a[64:67], a[184:187], v[100:103]
    ds_read_b128 a[172:175], v11 offset:52224
    s_add_u32 s97, s43, 28672
    v_mfma_f32_16x16x32_bf16 v[100:103], a[72:75], a[188:191], v[100:103]
    buffer_load_dwordx4 a[112:115], v1, s[8:11], s97 offen offset:0 sc1
    v_mfma_f32_16x16x32_bf16 v[104:107], a[68:71], a[184:187], v[104:107]
    v_mfma_f32_16x16x32_bf16 v[104:107], a[76:79], a[188:191], v[104:107]
    ds_read_b128 a[176:179], v10 offset:53248
    s_waitcnt lgkmcnt(5)
    v_mfma_f32_16x16x32_bf16 v[108:111], a[64:67], a[192:195], v[108:111]
    ds_read_b128 a[180:183], v11 offset:53248
    buffer_load_dwordx4 a[116:119], v1, s[8:11], s97 offen offset:1024 sc1
    v_mfma_f32_16x16x32_bf16 v[108:111], a[72:75], a[196:199], v[108:111]
    v_mfma_f32_16x16x32_bf16 v[112:115], a[68:71], a[192:195], v[112:115]
    v_mfma_f32_16x16x32_bf16 v[112:115], a[76:79], a[196:199], v[112:115]
    ds_read_b128 a[184:187], v10 offset:54272
    s_waitcnt vmcnt(15) lgkmcnt(5)
    v_mfma_f32_16x16x32_bf16 v[76:79], a[80:83], a[160:163], v[76:79]
    ds_read_b128 a[188:191], v11 offset:54272
    s_waitcnt vmcnt(13)
    v_mfma_f32_16x16x32_bf16 v[76:79], a[88:91], a[164:167], v[76:79]
    buffer_load_dwordx4 a[120:123], v1, s[8:11], s97 offen offset:2048 sc1
    v_mfma_f32_16x16x32_bf16 v[80:83], a[84:87], a[160:163], v[80:83]
    s_waitcnt vmcnt(13)
    v_mfma_f32_16x16x32_bf16 v[80:83], a[92:95], a[164:167], v[80:83]
    ds_read_b128 a[192:195], v10 offset:55296
    s_waitcnt lgkmcnt(5)
    v_mfma_f32_16x16x32_bf16 v[84:87], a[80:83], a[168:171], v[84:87]
    ds_read_b128 a[196:199], v11 offset:55296
    v_mfma_f32_16x16x32_bf16 v[84:87], a[88:91], a[172:175], v[84:87]
    buffer_load_dwordx4 a[124:127], v1, s[8:11], s97 offen offset:3072 sc1
    v_mfma_f32_16x16x32_bf16 v[88:91], a[84:87], a[168:171], v[88:91]
    v_mfma_f32_16x16x32_bf16 v[88:91], a[92:95], a[172:175], v[88:91]
    s_add_u32 m0, s45, 81920
    s_add_u32 s96, s61, 1024
    buffer_load_dwordx4 v5, s[16:19], s96 offen lds
    buffer_load_dwordx4 v6, s[16:19], s96 offen offset:1024 lds
    buffer_load_dwordx4 v7, s[16:19], s96 offen offset:2048 lds
    s_waitcnt vmcnt(12)
    s_barrier
    v_add_u32 v14, 61440, v10
    v_add_u32 v15, 61440, v11
    ds_read_b128 a[160:163], v14 offset:0
    s_waitcnt lgkmcnt(5)
    v_mfma_f32_16x16x32_bf16 v[92:95], a[80:83], a[176:179], v[92:95]
    ds_read_b128 a[164:167], v15 offset:0
    s_waitcnt vmcnt(10)
    v_cmp_ne_u32 vcc, s42, v212
    s_cbranch_vccnz L_slow1
L_ok1:
    v_mfma_f32_16x16x32_bf16 v[92:95], a[88:91], a[180:183], v[92:95]
    buffer_load_dwordx4 v8, s[16:19], s96 offen offset:3072 lds
    v_mfma_f32_16x16x32_bf16 v[96:99], a[84:87], a[176:179], v[96:99]
    v_mfma_f32_16x16x32_bf16 v[96:99], a[92:95], a[180:183], v[96:99]
    ds_read_b128 a[168:171], v14 offset:1024
    s_waitcnt lgkmcnt(5)
    v_mfma_f32_16x16x32_bf16 v[100:103], a[80:83], a[184:187], v[100:103]
    ds_read_b128 a[172:175], v15 offset:1024
    v_mfma_f32_16x16x32_bf16 v[100:103], a[88:91], a[188:191], v[100:103]
    v_mfma_f32_16x16x32_bf16 v[104:107], a[84:87], a[184:187], v[104:107]
    s_add_u32 m0, s45, 86016
    s_nop 0
    buffer_load_dwordx4 v9, s[16:19], s96 offen lds
    v_mfma_f32_16x16x32_bf16 v[104:107], a[92:95], a[188:191], v[104:107]
    ds_read_b128 a[176:179], v14 offset:2048
    s_and_b32 s53, s36, 1
    s_lshl_b32 s53, s53, 4
    v_xor_b32 v5, s53, v5
    s_waitcnt lgkmcnt(5)
    v_mfma_f32_16x16x32_bf16 v[108:111], a[80:83], a[192:195], v[108:111]
    ds_read_b128 a[180:183], v15 offset:2048
    v_add_u32 v6, 19456, v5
    v_add_u32 v7, 38912, v5
    v_mfma_f32_16x16x32_bf16 v[108:111], a[88:91], a[196:199], v[108:111]
    s_add_u32 s97, s43, 32768
    buffer_load_dwordx4 a[128:131], v1, s[8:11], s97 offen offset:0 sc1
    v_add_u32 v8, 58368, v5
    v_mfma_f32_16x16x32_bf16 v[112:115], a[84:87], a[192:195], v[112:115]
    v_add_u32 v9, 81920, v5
    s_lshl_b32 s3, s38, 10
    s_add_u32 s3, s3, s46
    v_mfma_f32_16x16x32_bf16 v[112:115], a[92:95], a[196:199], v[112:115]
    ds_read_b128 a[184:187], v14 offset:3072
    s_lshr_b32 s53, s2, 3
    s_add_u32 s53, s53, s40
    s_sub_u32 s53, 0, s53
    s_and_b32 s53, s53, 3
    s_cmp_eq_u32 s53, 1
    s_cselect_b32 s90, -1, 0
    s_cmp_eq_u32 s53, 0
    s_cselect_b32 s90, 1, s90
    s_waitcnt lgkmcnt(5)
    v_mfma_f32_16x16x32_bf16 v[76:79], a[96:99], a[160:163], v[76:79]
    ds_read_b128 a[188:191], v15 offset:3072
    s_lshr_b32 s53, s2, 3
    s_add_u32 s53, s53, s40
    s_sub_u32 s53, 1, s53
    s_and_b32 s53, s53, 3
    s_cmp_eq_u32 s53, 1
    s_cselect_b32 s93, -1, 0
    s_cmp_eq_u32 s53, 0
    s_cselect_b32 s93, 1, s93
    s_waitcnt vmcnt(11)
    v_mfma_f32_16x16x32_bf16 v[76:79], a[104:107], a[164:167], v[76:79]
    buffer_load_dwordx4 a[132:135], v1, s[8:11], s97 offen offset:1024 sc1
    s_lshr_b32 s53, s2, 3
    s_add_u32 s53, s53, s40
    s_sub_u32 s53, 2, s53
    s_and_b32 s53, s53, 3
    s_cmp_eq_u32 s53, 1
    s_cselect_b32 s94, -1, 0
    s_cmp_eq_u32 s53, 0
    s_cselect_b32 s94, 1, s94
    v_mfma_f32_16x16x32_bf16 v[80:83], a[100:103], a[160:163], v[80:83]
    s_lshr_b32 s53, s2, 3
    s_add_u32 s53, s53, s40
    s_sub_u32 s53, 3, s53
    s_and_b32 s53, s53, 3
    s_cmp_eq_u32 s53, 1
    s_cselect_b32 s84, -1, 0
    s_cmp_eq_u32 s53, 0
    s_cselect_b32 s84, 1, s84
    s_waitcnt vmcnt(11)
    v_mfma_f32_16x16x32_bf16 v[80:83], a[108:111], a[164:167], v[80:83]
    ds_read_b128 a[192:195], v14 offset:4096
    s_cmp_eq_u32 s41, 0
    s_cselect_b64 s[20:21], s[20:21], s[8:9]
    s_cselect_b64 s[16:17], s[24:25], s[8:9]
    s_cselect_b32 s22, s22, s10
    s_mov_b32 s18, s22
    s_waitcnt lgkmcnt(5)
    v_mfma_f32_16x16x32_bf16 v[84:87], a[96:99], a[168:171], v[84:87]
    ds_read_b128 a[196:199], v15 offset:4096
    buffer_load_dwordx4 a[136:139], v1, s[8:11], s97 offen offset:2048 sc1
    s_add_u32 s51, s48, 0
    s_sub_u32 s52, s49, 1280
    s_cmp_eq_u32 s41, 0
    s_cselect_b32 s28, s49, s51
    s_cselect_b32 s29, s52, s51
    v_mfma_f32_16x16x32_bf16 v[84:87], a[104:107], a[172:175], v[84:87]
    s_mul_i32 s30, s41, 20224
    s_add_u32 s30, s30, 256
    s_mul_i32 s31, s41, 40960
    s_add_u32 s31, s31, s46
    v_mfma_f32_16x16x32_bf16 v[88:91], a[100:103], a[168:171], v[88:91]
    buffer_load_dwordx4 a[140:143], v1, s[8:11], s97 offen offset:3072 sc1
    s_add_u32 s97, s43, 36864
    s_max_i32 s64, s90, 0
    s_add_u32 s64, s64, 0
    s_mul_i32 s64, s64, s30
    s_add_u32 s64, s64, s28
    v_mfma_f32_16x16x32_bf16 v[88:91], a[108:111], a[172:175], v[88:91]
    ds_read_b128 a[160:163], v14 offset:10240
    s_min_i32 s65, s93, 0
    s_add_u32 s65, s65, 1
    s_mul_i32 s65, s65, s30
    s_add_u32 s65, s65, s28
    s_waitcnt lgkmcnt(5)
    v_mfma_f32_16x16x32_bf16 v[92:95], a[96:99], a[176:179], v[92:95]
    ds_read_b128 a[164:167], v15 offset:10240
    buffer_load_dwordx4 a[144:147], v1, s[8:11], s97 offen offset:0 sc1
    s_max_i32 s66, s94, 0
    s_add_u32 s66, s66, 5
    s_mul_i32 s52, s41, -3
    s_add_u32 s66, s66, s52
    s_mul_i32 s66, s66, s30
    s_add_u32 s66, s66, s29
    v_mfma_f32_16x16x32_bf16 v[92:95], a[104:107], a[180:183], v[92:95]
    s_min_i32 s67, s84, 0
    s_add_u32 s67, s67, 6
    s_mul_i32 s52, s41, -3
    s_add_u32 s67, s67, s52
    s_mul_i32 s67, s67, s30
    s_add_u32 s67, s67, s29
    v_mfma_f32_16x16x32_bf16 v[96:99], a[100:103], a[176:179], v[96:99]
    buffer_load_dwordx4 a[148:151], v1, s[8:11], s97 offen offset:1024 sc1
    s_max_i32 s68, s90, 0
    s_add_u32 s68, s68, 2
    s_mul_i32 s52, s41, 2
    s_add_u32 s68, s68, s52
    s_mul_i32 s68, s68, s30
    s_add_u32 s68, s68, s28
    v_mfma_f32_16x16x32_bf16 v[96:99], a[108:111], a[180:183], v[96:99]
    ds_read_b128 a[168:171], v14 offset:11264
    s_add_u32 s69, s93, 3
    s_mul_i32 s52, s41, 2
    s_add_u32 s69, s69, s52
    s_mul_i32 s69, s69, s30
    s_add_u32 s69, s69, s28
    s_waitcnt lgkmcnt(5)
    v_mfma_f32_16x16x32_bf16 v[100:103], a[96:99], a[184:187], v[100:103]
    ds_read_b128 a[172:175], v15 offset:11264
    buffer_load_dwordx4 a[152:155], v1, s[8:11], s97 offen offset:2048 sc1
    s_min_i32 s70, s94, 0
    s_add_u32 s70, s70, 4
    s_mul_i32 s52, s41, 2
    s_add_u32 s70, s70, s52
    s_mul_i32 s70, s70, s30
    s_add_u32 s70, s70, s28
    v_mfma_f32_16x16x32_bf16 v[100:103], a[104:107], a[188:191], v[100:103]
    s_max_i32 s71, s84, 0
    s_add_u32 s71, s71, 7
    s_mul_i32 s71, s71, s30
    s_add_u32 s71, s71, s29
    v_mfma_f32_16x16x32_bf16 v[104:107], a[100:103], a[184:187], v[104:107]
    buffer_load_dwordx4 a[156:159], v1, s[8:11], s97 offen offset:3072 sc1
    s_add_u32 s72, s90, 8
    s_mul_i32 s72, s72, s30
    s_add_u32 s72, s72, s29
    v_mfma_f32_16x16x32_bf16 v[104:107], a[108:111], a[188:191], v[104:107]
    ds_read_b128 a[176:179], v14 offset:12288
    s_min_i32 s73, s93, 0
    s_add_u32 s73, s73, 9
    s_mul_i32 s73, s73, s30
    s_add_u32 s73, s73, s29
    s_waitcnt lgkmcnt(5)
    v_mfma_f32_16x16x32_bf16 v[108:111], a[96:99], a[192:195], v[108:111]
    ds_read_b128 a[180:183], v15 offset:12288
    s_add_u32 m0, s45, 102400
    s_add_u32 s74, s31, 0
    s_max_i32 s51, s90, 0
    s_mul_i32 s51, s51, 4096
    s_add_u32 s74, s74, s51
    v_mfma_f32_16x16x32_bf16 v[108:111], a[104:107], a[196:199], v[108:111]
    s_add_u32 s96, s44, 0
    buffer_load_dwordx4 v1, s[8:11], s96 offen sc1 lds
    s_add_u32 s75, s31, 4096
    s_min_i32 s51, s93, 0
    s_mul_i32 s51, s51, 4096
    s_add_u32 s75, s75, s51
    v_mfma_f32_16x16x32_bf16 v[112:115], a[100:103], a[192:195], v[112:115]
    s_add_u32 s76, s31, 20480
    s_mul_i32 s52, s41, -12288
    s_add_u32 s76, s76, s52
    s_max_i32 s51, s94, 0
    s_mul_i32 s51, s51, 4096
    s_add_u32 s76, s76, s51
    v_mfma_f32_16x16x32_bf16 v[112:115], a[108:111], a[196:199], v[112:115]
    ds_read_b128 a[184:187], v14 offset:13312
    s_add_u32 s77, s31, 24576
    s_mul_i32 s52, s41, -12288
    s_add_u32 s77, s77, s52
    s_min_i32 s51, s84, 0
    s_mul_i32 s51, s51, 4096
    s_add_u32 s77, s77, s51
    s_waitcnt vmcnt(17) lgkmcnt(5)
    v_mfma_f32_16x16x32_bf16 v[76:79], a[112:115], a[160:163], v[76:79]
    ds_read_b128 a[188:191], v15 offset:13312
    s_add_u32 s78, s31, 8192
    s_mul_i32 s52, s41, 8192
    s_add_u32 s78, s78, s52
    s_max_i32 s51, s90, 0
    s_mul_i32 s51, s51, 4096
    s_add_u32 s78, s78, s51
    s_waitcnt vmcnt(15)
    v_mfma_f32_16x16x32_bf16 v[76:79], a[120:123], a[164:167], v[76:79]
    buffer_load_dwordx4 v1, s[8:11], s96 offen offset:1024 sc1 lds
    s_add_u32 s79, s31, 12288
    s_mul_i32 s52, s41, 8192
    s_add_u32 s79, s79, s52
    s_mul_i32 s51, s93, 4096
    s_add_u32 s79, s79, s51
    v_mfma_f32_16x16x32_bf16 v[80:83], a[116:119], a[160:163], v[80:83]
    s_add_u32 s80, s31, 16384
    s_mul_i32 s52, s41, 8192
    s_add_u32 s80, s80, s52
    s_min_i32 s51, s94, 0
    s_mul_i32 s51, s51, 4096
    s_add_u32 s80, s80, s51
    s_waitcnt vmcnt(15)
    v_mfma_f32_16x16x32_bf16 v[80:83], a[124:127], a[164:167], v[80:83]
    ds_read_b128 a[192:195], v14 offset:14336
    s_add_u32 s81, s31, 28672
    s_max_i32 s51, s84, 0
    s_mul_i32 s51, s51, 4096
    s_add_u32 s81, s81, s51
    s_waitcnt lgkmcnt(5)
    v_mfma_f32_16x16x32_bf16 v[84:87], a[112:115], a[168:171], v[84:87]
    ds_read_b128 a[196:199], v15 offset:14336
    buffer_load_dwordx4 v1, s[8:11], s96 offen offset:2048 sc1 lds
    s_add_u32 s82, s31, 32768
    s_mul_i32 s51, s90, 4096
    s_add_u32 s82, s82, s51
    v_mfma_f32_16x16x32_bf16 v[84:87], a[120:123], a[172:175], v[84:87]
    s_add_u32 s83, s31, 36864
    s_min_i32 s51, s93, 0
    s_mul_i32 s51, s51, 4096
    s_add_u32 s83, s83, s51
    v_mfma_f32_16x16x32_bf16 v[88:91], a[116:119], a[168:171], v[88:91]
    v_mfma_f32_16x16x32_bf16 v[88:91], a[124:127], a[172:175], v[88:91]
    s_waitcnt vmcnt(11)
    s_barrier
    ds_read_b128 a[160:163], v14 offset:20480
    s_waitcnt lgkmcnt(5)
    v_mfma_f32_16x16x32_bf16 v[92:95], a[112:115], a[176:179], v[92:95]
    ds_read_b128 a[164:167], v15 offset:20480
    buffer_load_dwordx4 v1, s[8:11], s96 offen offset:3072 sc1 lds
    v_mfma_f32_16x16x32_bf16 v[92:95], a[120:123], a[180:183], v[92:95]
    s_add_u32 m0, s45, 106496
    v_mfma_f32_16x16x32_bf16 v[96:99], a[116:119], a[176:179], v[96:99]
    v_mfma_f32_16x16x32_bf16 v[96:99], a[124:127], a[180:183], v[96:99]
    ds_read_b128 a[168:171], v14 offset:30720
    s_waitcnt lgkmcnt(5)
    v_mfma_f32_16x16x32_bf16 v[100:103], a[112:115], a[184:187], v[100:103]
    ds_read_b128 a[172:175], v15 offset:30720
    buffer_load_dwordx4 v4, s[8:11], s96 offen sc1 lds
    v_mfma_f32_16x16x32_bf16 v[100:103], a[120:123], a[188:191], v[100:103]
    s_add_u32 m0, s45, 122880
    s_add_u32 s96, s44, 20480
    v_mfma_f32_16x16x32_bf16 v[104:107], a[116:119], a[184:187], v[104:107]
    v_mfma_f32_16x16x32_bf16 v[104:107], a[124:127], a[188:191], v[104:107]
    ds_read_b128 a[176:179], v14 offset:21504
    s_waitcnt lgkmcnt(5)
    v_mfma_f32_16x16x32_bf16 v[108:111], a[112:115], a[192:195], v[108:111]
    ds_read_b128 a[180:183], v15 offset:21504
    buffer_load_dwordx4 v1, s[8:11], s96 offen sc1 lds
    v_mfma_f32_16x16x32_bf16 v[108:111], a[120:123], a[196:199], v[108:111]
    v_mfma_f32_16x16x32_bf16 v[112:115], a[116:119], a[192:195], v[112:115]
    v_mfma_f32_16x16x32_bf16 v[112:115], a[124:127], a[196:199], v[112:115]
    ds_read_b128 a[184:187], v14 offset:31744
    s_waitcnt vmcnt(13) lgkmcnt(5)
    v_mfma_f32_16x16x32_bf16 v[76:79], a[128:131], a[160:163], v[76:79]
    ds_read_b128 a[188:191], v15 offset:31744
    s_waitcnt vmcnt(11)
    v_mfma_f32_16x16x32_bf16 v[76:79], a[136:139], a[164:167], v[76:79]
    buffer_load_dwordx4 v1, s[8:11], s96 offen offset:1024 sc1 lds
    v_mfma_f32_16x16x32_bf16 v[80:83], a[132:135], a[160:163], v[80:83]
    s_waitcnt vmcnt(11)
    v_mfma_f32_16x16x32_bf16 v[80:83], a[140:143], a[164:167], v[80:83]
    ds_read_b128 a[192:195], v14 offset:22528
    s_waitcnt vmcnt(10) lgkmcnt(5)
    v_mfma_f32_16x16x32_bf16 v[76:79], a[144:147], a[168:171], v[76:79]
    ds_read_b128 a[196:199], v15 offset:22528
    s_waitcnt vmcnt(8)
    v_mfma_f32_16x16x32_bf16 v[76:79], a[152:155], a[172:175], v[76:79]
    buffer_load_dwordx4 v1, s[8:11], s96 offen offset:2048 sc1 lds
    v_mfma_f32_16x16x32_bf16 v[80:83], a[148:151], a[168:171], v[80:83]
    s_waitcnt vmcnt(8)
    v_mfma_f32_16x16x32_bf16 v[80:83], a[156:159], a[172:175], v[80:83]
    ds_read_b128 a[160:163], v14 offset:32768
    s_waitcnt lgkmcnt(5)
    v_mfma_f32_16x16x32_bf16 v[84:87], a[128:131], a[176:179], v[84:87]
    ds_read_b128 a[164:167], v15 offset:32768
    buffer_load_dwordx4 v1, s[8:11], s96 offen offset:3072 sc1 lds
    v_fma_f32 v201, v22, v76, v77
    v_mfma_f32_16x16x32_bf16 v[84:87], a[136:139], a[180:183], v[84:87]
    s_add_u32 m0, s45, 126976
    v_fmac_f32_dpp v201, v76, v27 quad_perm:[1,0,3,2] row_mask:0xf bank_mask:0xf
    v_fma_f32 v196, v22, v201, v78
    v_mfma_f32_16x16x32_bf16 v[88:91], a[132:135], a[176:179], v[88:91]
    v_fmac_f32_dpp v196, v201, v27 quad_perm:[1,0,3,2] row_mask:0xf bank_mask:0xf
    v_fma_f32 v201, v22, v196, v79
    v_mfma_f32_16x16x32_bf16 v[88:91], a[140:143], a[180:183], v[88:91]
    ds_read_b128 a[168:171], v14 offset:23552
    v_fmac_f32_dpp v201, v196, v27 quad_perm:[1,0,3,2] row_mask:0xf bank_mask:0xf
L_pad1:
    s_cbranch_execz L_pad5
    s_waitcnt lgkmcnt(5)
    v_mfma_f32_16x16x32_bf16 v[84:87], a[144:147], a[184:187], v[84:87]
    ds_read_b128 a[172:175], v15 offset:23552
    buffer_load_dwordx4 v4, s[8:11], s96 offen sc1 lds
    v_fma_f32 v196, v22, v201, v80
    v_mfma_f32_16x16x32_bf16 v[84:87], a[152:155], a[188:191], v[84:87]
    v_fmac_f32_dpp v196, v201, v27 quad_perm:[1,0,3,2] row_mask:0xf bank_mask:0xf
    v_fma_f32 v201, v22, v196, v81
    v_mfma_f32_16x16x32_bf16 v[88:91], a[148:151], a[184:187], v[88:91]
    v_fmac_f32_dpp v201, v196, v27 quad_perm:[1,0,3,2] row_mask:0xf bank_mask:0xf
    v_fma_f32 v196, v22, v201, v82
    v_mfma_f32_16x16x32_bf16 v[88:91], a[156:159], a[188:191], v[88:91]
    ds_read_b128 a[176:179], v14 offset:33792
    v_fmac_f32_dpp v196, v201, v27 quad_perm:[1,0,3,2] row_mask:0xf bank_mask:0xf
    s_waitcnt lgkmcnt(5)
    v_mfma_f32_16x16x32_bf16 v[92:95], a[128:131], a[192:195], v[92:95]
    ds_read_b128 a[180:183], v15 offset:33792
    s_add_u32 m0, s45, 0
    v_fma_f32 v201, v22, v196, v83
    v_mfma_f32_16x16x32_bf16 v[92:95], a[136:139], a[196:199], v[92:95]
    s_add_u32 s96, s44, 40960
    buffer_load_dwordx4 v1, s[8:11], s96 offen sc1 lds
    v_fmac_f32_dpp v201, v196, v27 quad_perm:[1,0,3,2] row_mask:0xf bank_mask:0xf
    v_mfma_f32_16x16x32_bf16 v[96:99], a[132:135], a[192:195], v[96:99]
    ds_write_b32 v48, v201 offset:4
    v_fma_f32 v202, v23, v84, v85
    v_fmac_f32_dpp v202, v84, v28 quad_perm:[1,0,3,2] row_mask:0xf bank_mask:0xf
    v_mfma_f32_16x16x32_bf16 v[96:99], a[140:143], a[196:199], v[96:99]
    ds_read_b128 a[184:187], v14 offset:24576
    v_fma_f32 v197, v23, v202, v86
    s_waitcnt lgkmcnt(6)
    v_mfma_f32_16x16x32_bf16 v[92:95], a[144:147], a[160:163], v[92:95]
    ds_read_b128 a[188:191], v15 offset:24576
    buffer_load_dwordx4 v1, s[8:11], s96 offen offset:1024 sc1 lds
    v_fmac_f32_dpp v197, v202, v28 quad_perm:[1,0,3,2] row_mask:0xf bank_mask:0xf
    v_mfma_f32_16x16x32_bf16 v[92:95], a[152:155], a[164:167], v[92:95]
    v_fma_f32 v202, v23, v197, v87
    v_fmac_f32_dpp v202, v197, v28 quad_perm:[1,0,3,2] row_mask:0xf bank_mask:0xf
    v_fma_f32 v197, v23, v202, v88
    v_mfma_f32_16x16x32_bf16 v[96:99], a[148:151], a[160:163], v[96:99]
    v_fmac_f32_dpp v197, v202, v28 quad_perm:[1,0,3,2] row_mask:0xf bank_mask:0xf
    v_fma_f32 v202, v23, v197, v89
    v_mfma_f32_16x16x32_bf16 v[96:99], a[156:159], a[164:167], v[96:99]
    ds_read_b128 a[192:195], v14 offset:34816
    v_fmac_f32_dpp v202, v197, v28 quad_perm:[1,0,3,2] row_mask:0xf bank_mask:0xf
    s_waitcnt lgkmcnt(6)
    v_mfma_f32_16x16x32_bf16 v[100:103], a[128:131], a[168:171], v[100:103]
    ds_read_b128 a[196:199], v15 offset:34816
    v_fma_f32 v197, v23, v202, v90
    v_fmac_f32_dpp v197, v202, v28 quad_perm:[1,0,3,2] row_mask:0xf bank_mask:0xf
    v_mfma_f32_16x16x32_bf16 v[100:103], a[136:139], a[172:175], v[100:103]
    v_fma_f32 v202, v23, v197, v91
    v_fmac_f32_dpp v202, v197, v28 quad_perm:[1,0,3,2] row_mask:0xf bank_mask:0xf
    ds_write_b32 v48, v202 offset:1284
    v_mfma_f32_16x16x32_bf16 v[104:107], a[132:135], a[168:171], v[104:107]
    v_fma_f32 v203, v24, v92, v93
    buffer_load_dwordx4 v1, s[8:11], s96 offen offset:2048 sc1 lds
    v_fmac_f32_dpp v203, v92, v29 quad_perm:[1,0,3,2] row_mask:0xf bank_mask:0xf
    v_mfma_f32_16x16x32_bf16 v[104:107], a[140:143], a[172:175], v[104:107]
    v_fma_f32 v198, v24, v203, v94
    v_fmac_f32_dpp v198, v203, v29 quad_perm:[1,0,3,2] row_mask:0xf bank_mask:0xf
    v_fma_f32 v203, v24, v198, v95
    s_waitcnt vmcnt(8)
    s_barrier
    ds_read_b128 a[160:163], v2 offset:40960
    s_waitcnt lgkmcnt(7)
    v_mfma_f32_16x16x32_bf16 v[100:103], a[144:147], a[176:179], v[100:103]
    ds_read_b128 a[164:167], v2 offset:45056
    buffer_load_dwordx4 v1, s[8:11], s96 offen offset:3072 sc1 lds
    v_fmac_f32_dpp v203, v198, v29 quad_perm:[1,0,3,2] row_mask:0xf bank_mask:0xf
    v_mfma_f32_16x16x32_bf16 v[100:103], a[152:155], a[180:183], v[100:103]
    ds_read_b128 a[168:171], v2 offset:49152
    v_fma_f32 v198, v24, v203, v96
    v_fmac_f32_dpp v198, v203, v29 quad_perm:[1,0,3,2] row_mask:0xf bank_mask:0xf
    v_mfma_f32_16x16x32_bf16 v[104:107], a[148:151], a[176:179], v[104:107]
    ds_read_b128 a[172:175], v2 offset:53248
    s_add_u32 m0, s45, 4096
    v_fma_f32 v203, v24, v198, v97
    v_mfma_f32_16x16x32_bf16 v[104:107], a[156:159], a[180:183], v[104:107]
    ds_read_b128 a[176:179], v2 offset:57344
    v_fmac_f32_dpp v203, v198, v29 quad_perm:[1,0,3,2] row_mask:0xf bank_mask:0xf
    s_waitcnt lgkmcnt(8)
    v_mfma_f32_16x16x32_bf16 v[108:111], a[128:131], a[184:187], v[108:111]
    buffer_load_dwordx4 v4, s[8:11], s96 offen sc1 lds
    v_fma_f32 v198, v24, v203, v98
    v_fmac_f32_dpp v198, v203, v29 quad_perm:[1,0,3,2] row_mask:0xf bank_mask:0xf
    v_mfma_f32_16x16x32_bf16 v[108:111], a[136:139], a[188:191], v[108:111]
    s_add_u32 m0, s45, 20480
    s_add_u32 s96, s44, 61440
    v_fma_f32 v203, v24, v198, v99
    v_mfma_f32_16x16x32_bf16 v[112:115], a[132:135], a[184:187], v[112:115]
    v_fmac_f32_dpp v203, v198, v29 quad_perm:[1,0,3,2] row_mask:0xf bank_mask:0xf
    ds_write_b32 v48, v203 offset:2564
    v_fma_f32 v204, v25, v100, v101
    v_mfma_f32_16x16x32_bf16 v[112:115], a[140:143], a[188:191], v[112:115]
    buffer_load_dwordx4 v1, s[8:11], s96 offen sc1 lds
    v_fmac_f32_dpp v204, v100, v30 quad_perm:[1,0,3,2] row_mask:0xf bank_mask:0xf
    s_waitcnt lgkmcnt(7)
    v_mfma_f32_16x16x32_bf16 v[108:111], a[144:147], a[192:195], v[108:111]
    v_fma_f32 v199, v25, v204, v102
    v_fmac_f32_dpp v199, v204, v30 quad_perm:[1,0,3,2] row_mask:0xf bank_mask:0xf
    v_fma_f32 v204, v25, v199, v103
    v_mfma_f32_16x16x32_bf16 v[108:111], a[152:155], a[196:199], v[108:111]
    ds_read_b128 a[180:183], v2 offset:41984
    v_fmac_f32_dpp v204, v199, v30 quad_perm:[1,0,3,2] row_mask:0xf bank_mask:0xf
    v_fma_f32 v199, v25, v204, v104
    v_mfma_f32_16x16x32_bf16 v[112:115], a[148:151], a[192:195], v[112:115]
    ds_read_b128 a[184:187], v2 offset:46080
    buffer_load_dwordx4 v1, s[8:11], s96 offen offset:1024 sc1 lds
    v_fmac_f32_dpp v199, v204, v30 quad_perm:[1,0,3,2] row_mask:0xf bank_mask:0xf
    v_mfma_f32_16x16x32_bf16 v[112:115], a[156:159], a[196:199], v[112:115]
    ds_read_b128 a[188:191], v2 offset:50176
    v_fma_f32 v204, v25, v199, v105
    s_waitcnt lgkmcnt(4)
    v_mfma_f32_16x16x32_bf16 v[116:119], a[160:163], a[0:3], 0
    v_fmac_f32_dpp v204, v199, v30 quad_perm:[1,0,3,2] row_mask:0xf bank_mask:0xf
    v_fma_f32 v199, v25, v204, v106
    v_fma_f32 v205, v26, v108, v109
    v_mfma_f32_16x16x32_bf16 v[116:119], a[164:167], a[8:11], v[116:119]
    v_fmac_f32_dpp v199, v204, v30 quad_perm:[1,0,3,2] row_mask:0xf bank_mask:0xf
    v_fma_f32 v204, v25, v199, v107
    v_mfma_f32_16x16x32_bf16 v[116:119], a[168:171], a[16:19], v[116:119]
    ds_read_b128 a[192:195], v2 offset:54272
    buffer_load_dwordx4 v1, s[8:11], s96 offen offset:2048 sc1 lds
    v_fmac_f32_dpp v204, v199, v30 quad_perm:[1,0,3,2] row_mask:0xf bank_mask:0xf
    v_mfma_f32_16x16x32_bf16 v[116:119], a[172:175], a[24:27], v[116:119]
    ds_read_b128 a[196:199], v2 offset:58368
    v_fmac_f32_dpp v205, v108, v31 quad_perm:[1,0,3,2] row_mask:0xf bank_mask:0xf
    v_mfma_f32_16x16x32_bf16 v[116:119], a[176:179], a[32:35], v[116:119]
    ds_write_b32 v48, v204 offset:3844
    v_fma_f32 v200, v26, v205, v110
    v_fmac_f32_dpp v200, v205, v31 quad_perm:[1,0,3,2] row_mask:0xf bank_mask:0xf
    v_mfma_f32_16x16x32_bf16 v[120:123], a[160:163], a[4:7], 0
    v_fma_f32 v205, v26, v200, v111
    v_fmac_f32_dpp v205, v200, v31 quad_perm:[1,0,3,2] row_mask:0xf bank_mask:0xf
    v_mfma_f32_16x16x32_bf16 v[120:123], a[164:167], a[12:15], v[120:123]
    buffer_load_dwordx4 v1, s[8:11], s96 offen offset:3072 sc1 lds
    v_fma_f32 v200, v26, v205, v112
    v_fmac_f32_dpp v200, v205, v31 quad_perm:[1,0,3,2] row_mask:0xf bank_mask:0xf
    v_mfma_f32_16x16x32_bf16 v[120:123], a[168:171], a[20:23], v[120:123]
    v_fma_f32 v205, v26, v200, v113
    v_fmac_f32_dpp v205, v200, v31 quad_perm:[1,0,3,2] row_mask:0xf bank_mask:0xf
    v_mfma_f32_16x16x32_bf16 v[120:123], a[172:175], a[28:31], v[120:123]
    v_fma_f32 v200, v26, v205, v114
    v_fmac_f32_dpp v200, v205, v31 quad_perm:[1,0,3,2] row_mask:0xf bank_mask:0xf
    v_fma_f32 v205, v26, v200, v115
    v_mfma_f32_16x16x32_bf16 v[120:123], a[176:179], a[36:39], v[120:123]
    ds_read_b128 a[160:163], v2 offset:43008
    s_waitcnt lgkmcnt(2)
    v_mfma_f32_16x16x32_bf16 v[124:127], a[180:183], a[0:3], 0
    ds_read_b128 a[164:167], v2 offset:47104
    s_add_u32 m0, s45, 24576
    v_fmac_f32_dpp v205, v200, v31 quad_perm:[1,0,3,2] row_mask:0xf bank_mask:0xf
    v_mfma_f32_16x16x32_bf16 v[124:127], a[184:187], a[8:11], v[124:127]
    ds_read_b128 a[168:171], v2 offset:51200
    buffer_load_dwordx4 v4, s[8:11], s96 offen sc1 lds
    v_mfma_f32_16x16x32_bf16 v[124:127], a[188:191], a[16:19], v[124:127]
    ds_read_b128 a[172:175], v2 offset:55296
    v_mfma_f32_16x16x32_bf16 v[124:127], a[192:195], a[24:27], v[124:127]
    ds_read_b128 a[176:179], v2 offset:59392
    s_add_u32 m0, s45, 40960
    v_mfma_f32_16x16x32_bf16 v[124:127], a[196:199], a[32:35], v[124:127]
    s_add_u32 s96, s44, 81920
    ds_write_b32 v48, v205 offset:5124
    v_mul_f32 v75, v32, v76
    v_mfma_f32_16x16x32_bf16 v[128:131], a[180:183], a[4:7], 0
    v_fmac_f32_dpp v75, v76, v37 quad_perm:[1,0,3,2] row_mask:0xf bank_mask:0xf
    buffer_load_dwordx4 v1, s[8:11], s96 offen sc1 lds
    v_mfma_f32_16x16x32_bf16 v[128:131], a[184:187], a[12:15], v[128:131]
    v_mul_f32 v76, v32, v77
    v_fmac_f32_dpp v76, v77, v37 quad_perm:[1,0,3,2] row_mask:0xf bank_mask:0xf
    v_mul_f32 v77, v32, v78
    v_mfma_f32_16x16x32_bf16 v[128:131], a[188:191], a[20:23], v[128:131]
    v_fmac_f32_dpp v77, v78, v37 quad_perm:[1,0,3,2] row_mask:0xf bank_mask:0xf
    v_mul_f32 v78, v32, v79
    v_mfma_f32_16x16x32_bf16 v[128:131], a[192:195], a[28:31], v[128:131]
    v_fmac_f32_dpp v78, v79, v37 quad_perm:[1,0,3,2] row_mask:0xf bank_mask:0xf
    v_mul_f32 v79, v32, v80
    v_fmac_f32_dpp v79, v80, v37 quad_perm:[1,0,3,2] row_mask:0xf bank_mask:0xf
    v_mfma_f32_16x16x32_bf16 v[128:131], a[196:199], a[36:39], v[128:131]
    ds_read_b128 a[180:183], v2 offset:44032
    s_waitcnt lgkmcnt(2)
    v_mfma_f32_16x16x32_bf16 v[132:135], a[160:163], a[0:3], 0
    ds_read_b128 a[184:187], v2 offset:48128
    buffer_load_dwordx4 v1, s[8:11], s96 offen offset:1024 sc1 lds
    v_mul_f32 v80, v32, v81
    v_mfma_f32_16x16x32_bf16 v[132:135], a[164:167], a[8:11], v[132:135]
    ds_read_b128 a[188:191], v2 offset:52224
    v_fmac_f32_dpp v80, v81, v37 quad_perm:[1,0,3,2] row_mask:0xf bank_mask:0xf
    v_mfma_f32_16x16x32_bf16 v[132:135], a[168:171], a[16:19], v[132:135]
    ds_read_b128 a[192:195], v2 offset:56320
    v_mul_f32 v81, v32, v82
    v_fmac_f32_dpp v81, v82, v37 quad_perm:[1,0,3,2] row_mask:0xf bank_mask:0xf
    v_mfma_f32_16x16x32_bf16 v[132:135], a[172:175], a[24:27], v[132:135]
    ds_read_b128 a[196:199], v2 offset:60416
    v_mul_f32 v82, v32, v83
    v_mfma_f32_16x16x32_bf16 v[132:135], a[176:179], a[32:35], v[132:135]
    buffer_load_dwordx4 v1, s[8:11], s96 offen offset:2048 sc1 lds
    v_fmac_f32_dpp v82, v83, v37 quad_perm:[1,0,3,2] row_mask:0xf bank_mask:0xf
    v_mul_f32 v83, v33, v84
    v_mfma_f32_16x16x32_bf16 v[136:139], a[160:163], a[4:7], 0
    v_fmac_f32_dpp v83, v84, v38 quad_perm:[1,0,3,2] row_mask:0xf bank_mask:0xf
    v_mul_f32 v84, v33, v85
    v_mfma_f32_16x16x32_bf16 v[136:139], a[164:167], a[12:15], v[136:139]
    v_fmac_f32_dpp v84, v85, v38 quad_perm:[1,0,3,2] row_mask:0xf bank_mask:0xf
    v_mul_f32 v85, v33, v86
    v_fmac_f32_dpp v85, v86, v38 quad_perm:[1,0,3,2] row_mask:0xf bank_mask:0xf
    v_mfma_f32_16x16x32_bf16 v[136:139], a[168:171], a[20:23], v[136:139]
    v_mul_f32 v86, v33, v87
    v_fmac_f32_dpp v86, v87, v38 quad_perm:[1,0,3,2] row_mask:0xf bank_mask:0xf
    v_mfma_f32_16x16x32_bf16 v[136:139], a[172:175], a[28:31], v[136:139]
    v_mul_f32 v87, v33, v88
    buffer_load_dwordx4 v1, s[8:11], s96 offen offset:3072 sc1 lds
    v_fmac_f32_dpp v87, v88, v38 quad_perm:[1,0,3,2] row_mask:0xf bank_mask:0xf
    v_mfma_f32_16x16x32_bf16 v[136:139], a[176:179], a[36:39], v[136:139]
    s_waitcnt vmcnt(14)
    s_waitcnt lgkmcnt(5)
    s_barrier
    ds_read_b128 a[160:163], v3 offset:0
    s_waitcnt lgkmcnt(1)
    v_mfma_f32_16x16x32_bf16 v[140:143], a[180:183], a[0:3], 0
    ds_read_b128 a[164:167], v3 offset:4096
    v_mul_f32 v88, v33, v89
    v_fmac_f32_dpp v88, v89, v38 quad_perm:[1,0,3,2] row_mask:0xf bank_mask:0xf
    v_mfma_f32_16x16x32_bf16 v[140:143], a[184:187], a[8:11], v[140:143]
    ds_read_b128 a[168:171], v3 offset:8192
    s_add_u32 m0, s45, 45056
    v_mfma_f32_16x16x32_bf16 v[140:143], a[188:191], a[16:19], v[140:143]
    ds_read_b128 a[172:175], v3 offset:12288
    buffer_load_dwordx4 v4, s[8:11], s96 offen sc1 lds
    v_mul_f32 v89, v33, v90
    v_mfma_f32_16x16x32_bf16 v[140:143], a[192:195], a[24:27], v[140:143]
    ds_read_b128 a[176:179], v3 offset:16384
    v_fmac_f32_dpp v89, v90, v38 quad_perm:[1,0,3,2] row_mask:0xf bank_mask:0xf
    v_mfma_f32_16x16x32_bf16 v[140:143], a[196:199], a[32:35], v[140:143]
    ds_read_b128 v[180:183], v49 offset:16
    v_mul_f32 v90, v33, v91
    v_fmac_f32_dpp v90, v91, v38 quad_perm:[1,0,3,2] row_mask:0xf bank_mask:0xf
    v_mfma_f32_16x16x32_bf16 v[144:147], a[180:183], a[4:7], 0
    s_add_u32 m0, s45, 61440
    s_add_u32 s96, s44, 102400
    v_mfma_f32_16x16x32_bf16 v[144:147], a[184:187], a[12:15], v[144:147]
    buffer_load_dwordx4 v1, s[8:11], s96 offen sc1 lds
    ds_read_b128 v[184:187], v49 offset:32
    v_mul_f32 v91, v34, v92
    v_mfma_f32_16x16x32_bf16 v[144:147], a[188:191], a[20:23], v[144:147]
    ds_read_b128 v[188:191], v49 offset:48
    v_fmac_f32_dpp v91, v92, v39 quad_perm:[1,0,3,2] row_mask:0xf bank_mask:0xf
    v_mfma_f32_16x16x32_bf16 v[144:147], a[192:195], a[28:31], v[144:147]
    ds_read_b128 v[192:195], v49 offset:64
    v_mov_b32 v206, 0
    v_mul_f32 v92, v34, v93
    v_mfma_f32_16x16x32_bf16 v[144:147], a[196:199], a[36:39], v[144:147]
    ds_read_b128 a[180:183], v3 offset:1024
    s_waitcnt lgkmcnt(5)
    v_mfma_f32_16x16x32_bf16 v[116:119], a[160:163], a[40:43], v[116:119]
    ds_read_b128 a[184:187], v3 offset:5120
    buffer_load_dwordx4 v1, s[8:11], s96 offen offset:1024 sc1 lds
    v_fmac_f32_dpp v92, v93, v39 quad_perm:[1,0,3,2] row_mask:0xf bank_mask:0xf
    v_mfma_f32_16x16x32_bf16 v[116:119], a[164:167], a[48:51], v[116:119]
    ds_read_b128 a[188:191], v3 offset:9216
    v_mul_f32 v93, v34, v94
    v_mfma_f32_16x16x32_bf16 v[116:119], a[168:171], a[56:59], v[116:119]
    ds_read_b128 a[192:195], v3 offset:13312
    v_fmac_f32_dpp v93, v94, v39 quad_perm:[1,0,3,2] row_mask:0xf bank_mask:0xf
    v_mul_f32 v94, v34, v95
    v_mfma_f32_16x16x32_bf16 v[116:119], a[172:175], a[64:67], v[116:119]
    ds_read_b128 a[196:199], v3 offset:17408
    v_fmac_f32_dpp v94, v95, v39 quad_perm:[1,0,3,2] row_mask:0xf bank_mask:0xf
    v_mfma_f32_16x16x32_bf16 v[116:119], a[176:179], a[72:75], v[116:119]
    buffer_load_dwordx4 v1, s[8:11], s96 offen offset:2048 sc1 lds
    ds_read_b64_tr_b16 v[236:237], v70 offset:0
    v_mul_f32 v95, v34, v96
    v_mfma_f32_16x16x32_bf16 v[120:123], a[160:163], a[44:47], v[120:123]
    s_waitcnt lgkmcnt(9)
    v_fmac_f32 v181, v42, v180
    v_mfma_f32_16x16x32_bf16 v[120:123], a[164:167], a[52:55], v[120:123]
    v_fmac_f32_dpp v181, v180, v43 quad_perm:[1,0,3,2] row_mask:0xf bank_mask:0xf
    v_fmac_f32 v182, v42, v181
    ds_read_b64_tr_b16 v[238:239], v70 offset:512
    v_mfma_f32_16x16x32_bf16 v[120:123], a[168:171], a[60:63], v[120:123]
    v_fmac_f32_dpp v182, v181, v43 quad_perm:[1,0,3,2] row_mask:0xf bank_mask:0xf
    v_fmac_f32 v183, v42, v182
    v_mfma_f32_16x16x32_bf16 v[120:123], a[172:175], a[68:71], v[120:123]
    buffer_load_dwordx4 v1, s[8:11], s96 offen offset:3072 sc1 lds
    s_add_u32 m0, s45, 65536
    v_fmac_f32_dpp v183, v182, v43 quad_perm:[1,0,3,2] row_mask:0xf bank_mask:0xf
    v_mfma_f32_16x16x32_bf16 v[120:123], a[176:179], a[76:79], v[120:123]
    ds_read_b128 a[160:163], v3 offset:2048
    s_waitcnt lgkmcnt(3)
    v_mfma_f32_16x16x32_bf16 v[124:127], a[180:183], a[40:43], v[124:127]
    ds_read_b128 a[164:167], v3 offset:6144
    v_fmac_f32 v184, v42, v183
    v_fmac_f32_dpp v184, v183, v43 quad_perm:[1,0,3,2] row_mask:0xf bank_mask:0xf
    v_mfma_f32_16x16x32_bf16 v[124:127], a[184:187], a[48:51], v[124:127]
    ds_read_b128 a[168:171], v3 offset:10240
    v_fmac_f32 v185, v42, v184
    v_mfma_f32_16x16x32_bf16 v[124:127], a[188:191], a[56:59], v[124:127]
    ds_read_b128 a[172:175], v3 offset:14336
    buffer_load_dwordx4 v4, s[8:11], s96 offen sc1 lds
    v_fmac_f32_dpp v185, v184, v43 quad_perm:[1,0,3,2] row_mask:0xf bank_mask:0xf
    v_mfma_f32_16x16x32_bf16 v[124:127], a[192:195], a[64:67], v[124:127]
    ds_read_b128 a[176:179], v3 offset:18432
    s_add_u32 m0, s45, 81920
    v_mfma_f32_16x16x32_bf16 v[124:127], a[196:199], a[72:75], v[124:127]
    s_add_u32 s96, s44, 122880
    v_fmac_f32 v186, v42, v185
    v_fmac_f32_dpp v186, v185, v43 quad_perm:[1,0,3,2] row_mask:0xf bank_mask:0xf
    v_mfma_f32_16x16x32_bf16 v[128:131], a[180:183], a[44:47], v[128:131]
    v_fmac_f32 v187, v42, v186
    v_fmac_f32_dpp v187, v186, v43 quad_perm:[1,0,3,2] row_mask:0xf bank_mask:0xf
    v_mfma_f32_16x16x32_bf16 v[128:131], a[184:187], a[52:55], v[128:131]
    buffer_load_dwordx4 v1, s[8:11], s96 offen sc1 lds
    v_fmac_f32 v188, v42, v187
    v_fmac_f32_dpp v188, v187, v43 quad_perm:[1,0,3,2] row_mask:0xf bank_mask:0xf
    v_mfma_f32_16x16x32_bf16 v[128:131], a[188:191], a[60:63], v[128:131]
    v_fmac_f32 v189, v42, v188
    v_fmac_f32_dpp v189, v188, v43 quad_perm:[1,0,3,2] row_mask:0xf bank_mask:0xf
    v_mfma_f32_16x16x32_bf16 v[128:131], a[192:195], a[68:71], v[128:131]
    v_fmac_f32 v190, v42, v189
    v_fmac_f32_dpp v190, v189, v43 quad_perm:[1,0,3,2] row_mask:0xf bank_mask:0xf
    v_fmac_f32 v191, v42, v190
    v_mfma_f32_16x16x32_bf16 v[128:131], a[196:199], a[76:79], v[128:131]
    ds_read_b128 a[180:183], v3 offset:3072
    s_waitcnt lgkmcnt(1)
    v_mfma_f32_16x16x32_bf16 v[132:135], a[160:163], a[40:43], v[132:135]
    ds_read_b128 a[184:187], v3 offset:7168
    buffer_load_dwordx4 v1, s[8:11], s96 offen offset:1024 sc1 lds
    v_fmac_f32_dpp v191, v190, v43 quad_perm:[1,0,3,2] row_mask:0xf bank_mask:0xf
    v_mfma_f32_16x16x32_bf16 v[132:135], a[164:167], a[48:51], v[132:135]
    ds_read_b128 a[188:191], v3 offset:11264
    v_fmac_f32 v192, v42, v191
    v_mfma_f32_16x16x32_bf16 v[132:135], a[168:171], a[56:59], v[132:135]
    ds_read_b128 a[192:195], v3 offset:15360
    v_fmac_f32_dpp v192, v191, v43 quad_perm:[1,0,3,2] row_mask:0xf bank_mask:0xf
    v_fmac_f32 v193, v42, v192
    v_mfma_f32_16x16x32_bf16 v[132:135], a[172:175], a[64:67], v[132:135]
    ds_read_b128 a[196:199], v3 offset:19456
    v_fmac_f32_dpp v193, v192, v43 quad_perm:[1,0,3,2] row_mask:0xf bank_mask:0xf
    v_mfma_f32_16x16x32_bf16 v[132:135], a[176:179], a[72:75], v[132:135]
    buffer_load_dwordx4 v1, s[8:11], s96 offen offset:2048 sc1 lds
    v_fmac_f32 v194, v42, v193
    v_fmac_f32_dpp v194, v193, v43 quad_perm:[1,0,3,2] row_mask:0xf bank_mask:0xf
    v_mfma_f32_16x16x32_bf16 v[136:139], a[160:163], a[44:47], v[136:139]
    v_fma_f32 v20, v42, v194, v195
    v_fmac_f32_dpp v20, v194, v43 quad_perm:[1,0,3,2] row_mask:0xf bank_mask:0xf
    v_mfma_f32_16x16x32_bf16 v[136:139], a[164:167], a[52:55], v[136:139]
    s_mov_b64 s[54:55], 0xfffff
    v_cndmask_b32 v20, 0, v20, s[54:55]
    ds_read_b64_tr_b16 v[240:241], v70 offset:32
    v_mfma_f32_16x16x32_bf16 v[136:139], a[168:171], a[60:63], v[136:139]
    ds_read_b64_tr_b16 v[242:243], v70 offset:544
    s_add_u32 s53, s58, -640
    buffer_store_dwordx2 v[20:21], v63, s[8:11], s53 offen sc1
    v_mfma_f32_16x16x32_bf16 v[136:139], a[172:175], a[68:71], v[136:139]
    ds_write_b32 v49, v206 offset:12
    v_fmac_f32_dpp v95, v96, v39 quad_perm:[1,0,3,2] row_mask:0xf bank_mask:0xf
    v_mul_f32 v96, v34, v97
    v_mfma_f32_16x16x32_bf16 v[136:139], a[176:179], a[76:79], v[136:139]
    s_waitcnt vmcnt(19)
    s_barrier
    ds_read_b128 a[160:163], v1 offset:0
    s_waitcnt lgkmcnt(4)
    v_mfma_f32_16x16x32_bf16 v[140:143], a[180:183], a[40:43], v[140:143]
    ds_read_b128 a[164:167], v1 offset:4096
    buffer_load_dwordx4 v1, s[8:11], s96 offen offset:3072 sc1 lds
    v_fmac_f32_dpp v96, v97, v39 quad_perm:[1,0,3,2] row_mask:0xf bank_mask:0xf
    v_mfma_f32_16x16x32_bf16 v[140:143], a[184:187], a[48:51], v[140:143]
    ds_read_b128 a[168:171], v1 offset:8192
    s_add_u32 m0, s45, 86016
    v_mfma_f32_16x16x32_bf16 v[140:143], a[188:191], a[56:59], v[140:143]
    ds_read_b128 a[172:175], v1 offset:12288
    v_mul_f32 v97, v34, v98
    v_fmac_f32_dpp v97, v98, v39 quad_perm:[1,0,3,2] row_mask:0xf bank_mask:0xf
    v_mfma_f32_16x16x32_bf16 v[140:143], a[192:195], a[64:67], v[140:143]
    ds_read_b128 a[176:179], v1 offset:16384
    v_mul_f32 v98, v34, v99
    v_mfma_f32_16x16x32_bf16 v[140:143], a[196:199], a[72:75], v[140:143]
    ds_write_b128 v49, v[180:183] offset:16
    buffer_store_dwordx4 v[236:239], v1, s[8:11], s91 offen sc1
    v_fmac_f32_dpp v98, v99, v39 quad_perm:[1,0,3,2] row_mask:0xf bank_mask:0xf
    v_mfma_f32_16x16x32_bf16 v[144:147], a[180:183], a[44:47], v[144:147]
    v_mul_f32 v99, v35, v100
    v_fmac_f32_dpp v99, v100, v40 quad_perm:[1,0,3,2] row_mask:0xf bank_mask:0xf
    v_mfma_f32_16x16x32_bf16 v[144:147], a[184:187], a[52:55], v[144:147]
    v_mul_f32 v100, v35, v101
    v_fmac_f32_dpp v100, v101, v40 quad_perm:[1,0,3,2] row_mask:0xf bank_mask:0xf
    v_mul_f32 v101, v35, v102
    v_mfma_f32_16x16x32_bf16 v[144:147], a[188:191], a[60:63], v[144:147]
    v_fmac_f32_dpp v101, v102, v40 quad_perm:[1,0,3,2] row_mask:0xf bank_mask:0xf
    v_mul_f32 v102, v35, v103
    v_mfma_f32_16x16x32_bf16 v[144:147], a[192:195], a[68:71], v[144:147]
    buffer_load_dwordx4 v4, s[8:11], s96 offen sc1 lds
    s_add_u32 m0, s45, 102400
    ds_write_b128 v49, v[184:187] offset:32
    v_mfma_f32_16x16x32_bf16 v[144:147], a[196:199], a[76:79], v[144:147]
    ds_read_b128 a[180:183], v1 offset:1024
    s_waitcnt lgkmcnt(3)
    v_mfma_f32_16x16x32_bf16 v[116:119], a[160:163], a[80:83], v[116:119]
    ds_read_b128 a[184:187], v1 offset:5120
    s_add_u32 s96, s44, 143360
    v_fmac_f32_dpp v102, v103, v40 quad_perm:[1,0,3,2] row_mask:0xf bank_mask:0xf
    v_mfma_f32_16x16x32_bf16 v[116:119], a[164:167], a[88:91], v[116:119]
    ds_read_b128 a[188:191], v1 offset:9216
    buffer_store_dwordx4 v[240:243], v1, s[8:11], s92 offen sc1
    v_mfma_f32_16x16x32_bf16 v[116:119], a[168:171], a[96:99], v[116:119]
    ds_read_b128 a[192:195], v1 offset:13312
    v_mul_f32 v103, v35, v104
    v_fmac_f32_dpp v103, v104, v40 quad_perm:[1,0,3,2] row_mask:0xf bank_mask:0xf
    v_mfma_f32_16x16x32_bf16 v[116:119], a[172:175], a[104:107], v[116:119]
    ds_read_b128 a[196:199], v1 offset:17408
    v_mul_f32 v104, v35, v105
    v_mfma_f32_16x16x32_bf16 v[116:119], a[176:179], a[112:115], v[116:119]
    ds_write_b128 v49, v[188:191] offset:48
    v_fmac_f32_dpp v104, v105, v40 quad_perm:[1,0,3,2] row_mask:0xf bank_mask:0xf
    v_mul_f32 v105, v35, v106
    v_mfma_f32_16x16x32_bf16 v[120:123], a[160:163], a[84:87], v[120:123]
    buffer_load_dwordx4 v1, s[8:11], s96 offen sc1 lds
    v_fmac_f32_dpp v105, v106, v40 quad_perm:[1,0,3,2] row_mask:0xf bank_mask:0xf
    v_mfma_f32_16x16x32_bf16 v[120:123], a[164:167], a[92:95], v[120:123]
    v_mul_f32 v106, v35, v107
    v_fmac_f32_dpp v106, v107, v40 quad_perm:[1,0,3,2] row_mask:0xf bank_mask:0xf
    v_mul_f32 v107, v36, v108
    v_mfma_f32_16x16x32_bf16 v[120:123], a[168:171], a[100:103], v[120:123]
    v_fmac_f32_dpp v107, v108, v41 quad_perm:[1,0,3,2] row_mask:0xf bank_mask:0xf
    v_mul_f32 v108, v36, v109
    v_mfma_f32_16x16x32_bf16 v[120:123], a[172:175], a[108:111], v[120:123]
    ds_write_b128 v49, v[192:195] offset:64
    v_fmac_f32_dpp v108, v109, v41 quad_perm:[1,0,3,2] row_mask:0xf bank_mask:0xf
    v_mul_f32 v109, v36, v110
    v_mfma_f32_16x16x32_bf16 v[120:123], a[176:179], a[116:119], v[120:123]
    ds_read_b128 a[160:163], v1 offset:2048
    s_waitcnt lgkmcnt(3)
    v_mfma_f32_16x16x32_bf16 v[124:127], a[180:183], a[80:83], v[124:127]
    ds_read_b128 a[164:167], v1 offset:6144
    buffer_load_dwordx4 v1, s[8:11], s96 offen offset:1024 sc1 lds
    v_fmac_f32_dpp v109, v110, v41 quad_perm:[1,0,3,2] row_mask:0xf bank_mask:0xf
    v_mfma_f32_16x16x32_bf16 v[124:127], a[184:187], a[88:91], v[124:127]
    ds_read_b128 a[168:171], v1 offset:10240
    v_mul_f32 v110, v36, v111
    v_mfma_f32_16x16x32_bf16 v[124:127], a[188:191], a[96:99], v[124:127]
    ds_read_b128 a[172:175], v1 offset:14336
    v_fmac_f32_dpp v110, v111, v41 quad_perm:[1,0,3,2] row_mask:0xf bank_mask:0xf
    v_mul_f32 v111, v36, v112
    v_mfma_f32_16x16x32_bf16 v[124:127], a[192:195], a[104:107], v[124:127]
    ds_read_b128 a[176:179], v1 offset:18432
    v_fmac_f32_dpp v111, v112, v41 quad_perm:[1,0,3,2] row_mask:0xf bank_mask:0xf
    v_mfma_f32_16x16x32_bf16 v[124:127], a[196:199], a[112:115], v[124:127]
    buffer_load_dwordx4 v1, s[8:11], s96 offen offset:2048 sc1 lds
    v_mul_f32 v112, v36, v113
    v_fmac_f32_dpp v112, v113, v41 quad_perm:[1,0,3,2] row_mask:0xf bank_mask:0xf
    v_mfma_f32_16x16x32_bf16 v[128:131], a[180:183], a[84:87], v[128:131]
    v_mul_f32 v113, v36, v114
    v_fmac_f32_dpp v113, v114, v41 quad_perm:[1,0,3,2] row_mask:0xf bank_mask:0xf
    v_mfma_f32_16x16x32_bf16 v[128:131], a[184:187], a[92:95], v[128:131]
    v_mul_f32 v114, v36, v115
    v_fmac_f32_dpp v114, v115, v41 quad_perm:[1,0,3,2] row_mask:0xf bank_mask:0xf
    v_mfma_f32_16x16x32_bf16 v[128:131], a[188:191], a[100:103], v[128:131]
    v_mfma_f32_16x16x32_bf16 v[128:131], a[192:195], a[108:111], v[128:131]
    buffer_load_dwordx4 v1, s[8:11], s96 offen offset:3072 sc1 lds
    s_add_u32 m0, s45, 106496
    v_mfma_f32_16x16x32_bf16 v[128:131], a[196:199], a[116:119], v[128:131]
    ds_read_b128 a[180:183], v1 offset:3072
    s_waitcnt lgkmcnt(1)
    v_mfma_f32_16x16x32_bf16 v[132:135], a[160:163], a[80:83], v[132:135]
    ds_read_b128 a[184:187], v1 offset:7168
    s_barrier
    v_mfma_f32_16x16x32_bf16 v[132:135], a[164:167], a[88:91], v[132:135]
    ds_read_b128 a[188:191], v1 offset:11264
    buffer_load_dwordx4 v4, s[8:11], s96 offen sc1 lds
    v_mfma_f32_16x16x32_bf16 v[132:135], a[168:171], a[96:99], v[132:135]
    ds_read_b128 a[192:195], v1 offset:15360
    v_mfma_f32_16x16x32_bf16 v[132:135], a[172:175], a[104:107], v[132:135]
    ds_read_b128 a[196:199], v1 offset:19456
    s_add_u32 m0, s45, 122880
    v_mfma_f32_16x16x32_bf16 v[132:135], a[176:179], a[112:115], v[132:135]
    s_add_u32 s96, s44, 163840
    ds_read_b32 v185, v48 offset:0
    v_mfma_f32_16x16x32_bf16 v[136:139], a[160:163], a[84:87], v[136:139]
    ds_read_b32 v186, v48 offset:1280
    v_mfma_f32_16x16x32_bf16 v[136:139], a[164:167], a[92:95], v[136:139]
    buffer_load_dwordx4 v1, s[8:11], s96 offen sc1 lds
    ds_read_b32 v187, v48 offset:2560
    v_mfma_f32_16x16x32_bf16 v[136:139], a[168:171], a[100:103], v[136:139]
    ds_read_b32 v188, v48 offset:3840
    v_mfma_f32_16x16x32_bf16 v[136:139], a[172:175], a[108:111], v[136:139]
    ds_read_b32 v189, v48 offset:5120
    v_mfma_f32_16x16x32_bf16 v[136:139], a[176:179], a[116:119], v[136:139]
    s_waitcnt vmcnt(19)
    s_barrier
    ds_read_b128 a[160:163], v1 offset:20480
    s_waitcnt lgkmcnt(6)
    v_mfma_f32_16x16x32_bf16 v[140:143], a[180:183], a[80:83], v[140:143]
    ds_read_b128 a[164:167], v1 offset:24576
    buffer_load_dwordx4 v1, s[8:11], s96 offen offset:1024 sc1 lds
    v_mfma_f32_16x16x32_bf16 v[140:143], a[184:187], a[88:91], v[140:143]
    ds_read_b128 a[168:171], v1 offset:28672
    v_mfma_f32_16x16x32_bf16 v[140:143], a[188:191], a[96:99], v[140:143]
    ds_read_b128 a[172:175], v1 offset:32768
    v_mfma_f32_16x16x32_bf16 v[140:143], a[192:195], a[104:107], v[140:143]
    ds_read_b128 a[176:179], v1 offset:36864
    v_mfma_f32_16x16x32_bf16 v[140:143], a[196:199], a[112:115], v[140:143]
    s_waitcnt lgkmcnt(9)
    v_mul_f32 v180, v32, v185
    v_mfma_f32_16x16x32_bf16 v[144:147], a[180:183], a[84:87], v[144:147]
    buffer_load_dwordx4 v1, s[8:11], s96 offen offset:2048 sc1 lds
    v_mfma_f32_16x16x32_bf16 v[144:147], a[184:187], a[92:95], v[144:147]
    s_waitcnt lgkmcnt(8)
    v_mul_f32 v181, v33, v186
    v_mfma_f32_16x16x32_bf16 v[144:147], a[188:191], a[100:103], v[144:147]
    s_waitcnt lgkmcnt(7)
    v_mul_f32 v182, v34, v187
    v_mfma_f32_16x16x32_bf16 v[144:147], a[192:195], a[108:111], v[144:147]
    s_waitcnt lgkmcnt(6)
    v_mul_f32 v183, v35, v188
    v_mfma_f32_16x16x32_bf16 v[144:147], a[196:199], a[116:119], v[144:147]
    ds_read_b128 a[180:183], v1 offset:21504
    s_waitcnt lgkmcnt(1)
    v_mfma_f32_16x16x32_bf16 v[116:119], a[160:163], a[120:123], v[116:119]
    ds_read_b128 a[184:187], v1 offset:25600
    buffer_load_dwordx4 v1, s[8:11], s96 offen offset:3072 sc1 lds
    v_mul_f32 v184, v36, v189
    v_mfma_f32_16x16x32_bf16 v[116:119], a[164:167], a[128:131], v[116:119]
    ds_read_b128 a[188:191], v1 offset:29696
    s_add_u32 m0, s45, 126976
    v_mfma_f32_16x16x32_bf16 v[116:119], a[168:171], a[136:139], v[116:119]
    ds_read_b128 a[192:195], v1 offset:33792
    v_fmac_f32_dpp v180, v185, v37 quad_perm:[1,0,3,2] row_mask:0xf bank_mask:0xf
    v_fmac_f32_dpp v181, v186, v38 quad_perm:[1,0,3,2] row_mask:0xf bank_mask:0xf
    v_mfma_f32_16x16x32_bf16 v[116:119], a[172:175], a[144:147], v[116:119]
    ds_read_b128 a[196:199], v1 offset:37888
    v_fmac_f32_dpp v182, v187, v39 quad_perm:[1,0,3,2] row_mask:0xf bank_mask:0xf
    v_mfma_f32_16x16x32_bf16 v[116:119], a[176:179], a[152:155], v[116:119]
    buffer_load_dwordx4 v4, s[8:11], s96 offen sc1 lds
    v_fmac_f32_dpp v183, v188, v40 quad_perm:[1,0,3,2] row_mask:0xf bank_mask:0xf
    v_fmac_f32_dpp v184, v189, v41 quad_perm:[1,0,3,2] row_mask:0xf bank_mask:0xf
    v_mfma_f32_16x16x32_bf16 v[120:123], a[160:163], a[124:127], v[120:123]
    v_mfma_f32_16x16x32_bf16 v[120:123], a[164:167], a[132:135], v[120:123]
    v_mfma_f32_16x16x32_bf16 v[120:123], a[168:171], a[140:143], v[120:123]
    v_mfma_f32_16x16x32_bf16 v[120:123], a[172:175], a[148:151], v[120:123]
    buffer_load_dwordx2 v[196:197], v62, s[8:11], s58 offen offset:0 sc1
    v_mul_f32 v116, 0xbfb8aa3b, v116
    v_mul_f32 v117, 0xbfb8aa3b, v117
    v_mfma_f32_16x16x32_bf16 v[120:123], a[176:179], a[156:159], v[120:123]
    ds_read_b128 a[160:163], v1 offset:22528
    s_waitcnt lgkmcnt(1)
    v_mfma_f32_16x16x32_bf16 v[124:127], a[180:183], a[120:123], v[124:127]
    ds_read_b128 a[164:167], v1 offset:26624
    v_exp_f32 v116, v116
    v_mfma_f32_16x16x32_bf16 v[124:127], a[184:187], a[128:131], v[124:127]
    ds_read_b128 a[168:171], v1 offset:30720
    buffer_load_dwordx2 v[198:199], v62, s[8:11], s58 offen offset:640 sc1
    v_mfma_f32_16x16x32_bf16 v[124:127], a[188:191], a[136:139], v[124:127]
    ds_read_b128 a[172:175], v1 offset:34816
    s_waitcnt vmcnt(12)
    s_barrier
    v_mfma_f32_16x16x32_bf16 v[124:127], a[192:195], a[144:147], v[124:127]
    ds_read_b128 a[176:179], v1 offset:38912
    s_add_u32 m0, s45, 0
    v_mfma_f32_16x16x32_bf16 v[124:127], a[196:199], a[152:155], v[124:127]
    s_add_u32 s96, s44, 184320
    buffer_load_dwordx2 v[200:201], v62, s[8:11], s58 offen offset:1280 sc1
L_pad2:
    s_cbranch_execz L_pad6
    v_mul_f32 v118, 0xbfb8aa3b, v118
    v_mfma_f32_16x16x32_bf16 v[128:131], a[180:183], a[124:127], v[128:131]
    v_exp_f32 v117, v117
    v_mfma_f32_16x16x32_bf16 v[128:131], a[184:187], a[132:135], v[128:131]
    v_add_f32 v116, 1.0, v116
    v_add_f32 v117, 1.0, v117
    v_mul_f32 v119, 0xbfb8aa3b, v119
    v_mfma_f32_16x16x32_bf16 v[128:131], a[188:191], a[140:143], v[128:131]
    buffer_load_dwordx2 v[202:203], v62, s[8:11], s58 offen offset:1920 sc1
    v_mul_f32 v124, 0xbfb8aa3b, v124
    v_mfma_f32_16x16x32_bf16 v[128:131], a[192:195], a[148:151], v[128:131]
    v_rcp_f32 v116, v116
    v_mul_f32 v125, 0xbfb8aa3b, v125
    v_mfma_f32_16x16x32_bf16 v[128:131], a[196:199], a[156:159], v[128:131]
    ds_read_b128 a[180:183], v1 offset:23552
    s_waitcnt lgkmcnt(1)
    v_mfma_f32_16x16x32_bf16 v[132:135], a[160:163], a[120:123], v[132:135]
    ds_read_b128 a[184:187], v1 offset:27648
    buffer_load_dwordx2 v[204:205], v62, s[8:11], s58 offen offset:2560 sc1
    v_mul_f32 v126, 0xbfb8aa3b, v126
    v_mfma_f32_16x16x32_bf16 v[132:135], a[164:167], a[128:131], v[132:135]
    ds_read_b128 a[188:191], v1 offset:31744
    v_mul_f32 v127, 0xbfb8aa3b, v127
    v_mfma_f32_16x16x32_bf16 v[132:135], a[168:171], a[136:139], v[132:135]
    ds_read_b128 a[192:195], v1 offset:35840
    v_rcp_f32 v117, v117
    v_mfma_f32_16x16x32_bf16 v[132:135], a[172:175], a[144:147], v[132:135]
    ds_read_b128 a[196:199], v1 offset:39936
    s_lshl2_add_u32 s53, s2, 321536
    s_cmp_eq_u32 s36, 0
    s_cselect_b32 s53, s53, 2146435072
    buffer_store_dword v21, v18, s[8:11], s53 offen sc1
    v_mfma_f32_16x16x32_bf16 v[132:135], a[176:179], a[152:155], v[132:135]
    v_exp_f32 v118, v118
    v_mul_f32 v120, 0xbfb8aa3b, v120
    v_mfma_f32_16x16x32_bf16 v[136:139], a[160:163], a[124:127], v[136:139]
    buffer_load_dwordx2 v[236:237], v69, s[4:7], s99 offen offset:0
    v_mul_f32 v121, 0xbfb8aa3b, v121
    v_mfma_f32_16x16x32_bf16 v[136:139], a[164:167], a[132:135], v[136:139]
    v_exp_f32 v119, v119
    v_add_f32 v118, 1.0, v118
    v_mfma_f32_16x16x32_bf16 v[136:139], a[168:171], a[140:143], v[136:139]
    v_exp_f32 v124, v124
    v_mfma_f32_16x16x32_bf16 v[136:139], a[172:175], a[148:151], v[136:139]
    v_exp_f32 v125, v125
    v_add_f32 v119, 1.0, v119
    v_mfma_f32_16x16x32_bf16 v[136:139], a[176:179], a[156:159], v[136:139]
    ds_read_b128 a[160:163], v1 offset:40960
    s_waitcnt lgkmcnt(1)
    v_mfma_f32_16x16x32_bf16 v[140:143], a[180:183], a[120:123], v[140:143]
    ds_read_b128 a[164:167], v1 offset:45056
    buffer_load_dwordx4 v1, s[8:11], s96 offen sc1 lds
    v_add_f32 v124, 1.0, v124
    v_mfma_f32_16x16x32_bf16 v[140:143], a[184:187], a[128:131], v[140:143]
    ds_read_b128 a[168:171], v1 offset:49152
    v_add_f32 v125, 1.0, v125
    v_mfma_f32_16x16x32_bf16 v[140:143], a[188:191], a[136:139], v[140:143]
    ds_read_b128 a[172:175], v1 offset:53248
    v_rcp_f32 v118, v118
    v_mfma_f32_16x16x32_bf16 v[140:143], a[192:195], a[144:147], v[140:143]
    ds_read_b128 a[176:179], v1 offset:57344
    v_mul_f32 v122, 0xbfb8aa3b, v122
    v_mfma_f32_16x16x32_bf16 v[140:143], a[196:199], a[152:155], v[140:143]
    buffer_load_dwordx2 v[238:239], v69, s[4:7], s99 offen offset:32
    v_rcp_f32 v119, v119
    v_mfma_f32_16x16x32_bf16 v[144:147], a[180:183], a[124:127], v[144:147]
    v_rcp_f32 v124, v124
    v_mfma_f32_16x16x32_bf16 v[144:147], a[184:187], a[132:135], v[144:147]
    v_rcp_f32 v125, v125
    v_mul_f32 v123, 0xbfb8aa3b, v123
    v_mfma_f32_16x16x32_bf16 v[144:147], a[188:191], a[140:143], v[144:147]
    v_exp_f32 v126, v126
    v_mfma_f32_16x16x32_bf16 v[144:147], a[192:195], a[148:151], v[144:147]
    buffer_load_dwordx4 v1, s[8:11], s96 offen offset:1024 sc1 lds
    v_exp_f32 v127, v127
    v_mfma_f32_16x16x32_bf16 v[144:147], a[196:199], a[156:159], v[144:147]
    ds_read_b128 a[180:183], v1 offset:41984
    s_waitcnt lgkmcnt(1)
    v_mfma_f32_16x16x32_bf16 v[148:151], a[160:163], a[0:3], 0
    ds_read_b128 a[184:187], v1 offset:46080
    v_mul_f32 v116, v116, v132
    v_mul_f32 v117, v117, v133
    v_mfma_f32_16x16x32_bf16 v[148:151], a[164:167], a[8:11], v[148:151]
    ds_read_b128 a[188:191], v1 offset:50176
    buffer_load_dwordx2 v[240:241], v69, s[4:7], s99 offen offset:64
    v_cvt_pk_bf16_f32 v132, v116, v117
    v_mfma_f32_16x16x32_bf16 v[148:151], a[168:171], a[16:19], v[148:151]
    ds_read_b128 a[192:195], v1 offset:54272
    v_mul_f32 v118, v118, v134
    v_mul_f32 v119, v119, v135
    v_mfma_f32_16x16x32_bf16 v[148:151], a[172:175], a[24:27], v[148:151]
    ds_read_b128 a[196:199], v1 offset:58368
    v_cvt_pk_bf16_f32 v133, v118, v119
    v_mul_f32 v124, v124, v140
    v_mfma_f32_16x16x32_bf16 v[148:151], a[176:179], a[32:35], v[148:151]
    v_mul_f32 v125, v125, v141
    buffer_load_dwordx4 v1, s[8:11], s96 offen offset:2048 sc1 lds
    v_cvt_pk_bf16_f32 v134, v124, v125
    v_mfma_f32_16x16x32_bf16 v[152:155], a[160:163], a[4:7], 0
    v_add_f32 v126, 1.0, v126
    v_add_f32 v127, 1.0, v127
    v_mul_f32 v128, 0xbfb8aa3b, v128
    v_mfma_f32_16x16x32_bf16 v[152:155], a[164:167], a[12:15], v[152:155]
    v_rcp_f32 v126, v126
    v_mul_f32 v129, 0xbfb8aa3b, v129
    v_mfma_f32_16x16x32_bf16 v[152:155], a[168:171], a[20:23], v[152:155]
    v_rcp_f32 v127, v127
    buffer_load_dwordx2 v[242:243], v69, s[4:7], s99 offen offset:96
    v_mfma_f32_16x16x32_bf16 v[152:155], a[172:175], a[28:31], v[152:155]
    v_mul_f32 v126, v126, v142
    v_mul_f32 v127, v127, v143
    v_cvt_pk_bf16_f32 v135, v126, v127
    v_mfma_f32_16x16x32_bf16 v[152:155], a[176:179], a[36:39], v[152:155]
    ds_read_b128 a[160:163], v1 offset:43008
    v_mul_f32 v130, 0xbfb8aa3b, v130
    s_waitcnt lgkmcnt(1)
    v_mfma_f32_16x16x32_bf16 v[156:159], a[180:183], a[0:3], 0
    ds_read_b128 a[164:167], v1 offset:47104
    v_exp_f32 v120, v120
    v_mfma_f32_16x16x32_bf16 v[156:159], a[184:187], a[8:11], v[156:159]
    ds_read_b128 a[168:171], v1 offset:51200
    s_add_u32 s53, s3, 40960
    buffer_store_dwordx4 v[132:135], v1, s[8:11], s53 offen sc1
    v_mfma_f32_16x16x32_bf16 v[156:159], a[188:191], a[16:19], v[156:159]
    ds_read_b128 a[172:175], v1 offset:55296
    v_exp_f32 v121, v121
    v_mfma_f32_16x16x32_bf16 v[156:159], a[192:195], a[24:27], v[156:159]
    ds_read_b128 a[176:179], v1 offset:59392
    s_waitcnt vmcnt(9)
    v_bitop3_b32 v197, v197, v199, s42 bitop3:126
    v_mfma_f32_16x16x32_bf16 v[156:159], a[196:199], a[32:35], v[156:159]
    v_bitop3_b32 v197, v197, v201, s42 bitop3:246
    v_bitop3_b32 v197, v197, v203, s42 bitop3:246
    v_bitop3_b32 v197, v197, v205, s42 bitop3:246
    v_mfma_f32_16x16x32_bf16 v[160:163], a[180:183], a[4:7], 0
    v_cmp_ne_u32 vcc, 0, v197
    s_cbranch_vccnz L_slow2
L_ok2:
    v_fmac_f32 v198, v44, v196
    v_mfma_f32_16x16x32_bf16 v[160:163], a[184:187], a[12:15], v[160:163]
    v_fmac_f32_dpp v198, v196, v45 quad_perm:[1,0,3,2] row_mask:0xf bank_mask:0xf
    v_fmac_f32 v200, v44, v198
    buffer_load_dwordx2 v[244:245], v69, s[4:7], s99 offen offset:128
    v_mfma_f32_16x16x32_bf16 v[160:163], a[188:191], a[20:23], v[160:163]
    v_fmac_f32_dpp v200, v198, v45 quad_perm:[1,0,3,2] row_mask:0xf bank_mask:0xf
    v_fmac_f32 v202, v44, v200
    v_add_f32 v120, 1.0, v120
    v_mfma_f32_16x16x32_bf16 v[160:163], a[192:195], a[28:31], v[160:163]
    v_fmac_f32_dpp v202, v200, v45 quad_perm:[1,0,3,2] row_mask:0xf bank_mask:0xf
    v_fmac_f32 v204, v44, v202
    v_add_f32 v121, 1.0, v121
    v_mfma_f32_16x16x32_bf16 v[160:163], a[196:199], a[36:39], v[160:163]
    ds_read_b128 a[180:183], v1 offset:44032
    v_fmac_f32_dpp v204, v202, v45 quad_perm:[1,0,3,2] row_mask:0xf bank_mask:0xf
    s_waitcnt lgkmcnt(1)
    v_mfma_f32_16x16x32_bf16 v[164:167], a[160:163], a[0:3], 0
    ds_read_b128 a[184:187], v1 offset:48128
    buffer_load_dwordx4 v1, s[8:11], s96 offen offset:3072 sc1 lds
    v_mul_f32 v207, v46, v204
    v_mfma_f32_16x16x32_bf16 v[164:167], a[164:167], a[8:11], v[164:167]
    ds_read_b128 a[188:191], v1 offset:52224
    s_add_u32 m0, s45, 4096
    v_fmac_f32_dpp v207, v204, v47 quad_perm:[1,0,3,2] row_mask:0xf bank_mask:0xf
    v_mfma_f32_16x16x32_bf16 v[164:167], a[168:171], a[16:19], v[164:167]
    ds_read_b128 a[192:195], v1 offset:56320
    v_rcp_f32 v120, v120
    v_mfma_f32_16x16x32_bf16 v[164:167], a[172:175], a[24:27], v[164:167]
    ds_read_b128 a[196:199], v1 offset:60416
    v_rcp_f32 v121, v121
    v_mfma_f32_16x16x32_bf16 v[164:167], a[176:179], a[32:35], v[164:167]
    buffer_load_dwordx4 v4, s[8:11], s96 offen sc1 lds
    ds_write_b32 v50, v207
    v_mul_f32 v120, v120, v136
    v_mfma_f32_16x16x32_bf16 v[168:171], a[160:163], a[4:7], 0
    v_exp_f32 v122, v122
    v_mul_f32 v121, v121, v137
    v_mfma_f32_16x16x32_bf16 v[168:171], a[164:167], a[12:15], v[168:171]
    v_exp_f32 v123, v123
    v_cvt_pk_bf16_f32 v136, v120, v121
    v_mfma_f32_16x16x32_bf16 v[168:171], a[168:171], a[20:23], v[168:171]
    v_exp_f32 v128, v128
    v_add_f32 v122, 1.0, v122
    v_mfma_f32_16x16x32_bf16 v[168:171], a[172:175], a[28:31], v[168:171]
    v_exp_f32 v129, v129
    v_add_f32 v123, 1.0, v123
    v_mfma_f32_16x16x32_bf16 v[168:171], a[176:179], a[36:39], v[168:171]
    s_barrier
    ds_read_b128 a[160:163], v2 offset:0
    s_waitcnt lgkmcnt(2)
    v_mfma_f32_16x16x32_bf16 v[172:175], a[180:183], a[0:3], 0
    ds_read_b128 a[164:167], v2 offset:4096
    s_add_u32 m0, s45, 20480
    s_waitcnt lgkmcnt(2)
    s_barrier
    v_mfma_f32_16x16x32_bf16 v[172:175], a[184:187], a[8:11], v[172:175]
    ds_read_b128 a[168:171], v2 offset:8192
    s_add_u32 s96, s44, 204800
    v_add_f32 v128, 1.0, v128
    v_mfma_f32_16x16x32_bf16 v[172:175], a[188:191], a[16:19], v[172:175]
    ds_read_b128 a[172:175], v2 offset:12288
    buffer_load_dwordx4 v1, s[8:11], s96 offen sc1 lds
    v_add_f32 v129, 1.0, v129
    v_mfma_f32_16x16x32_bf16 v[172:175], a[192:195], a[24:27], v[172:175]
    ds_read_b128 a[176:179], v2 offset:16384
    v_rcp_f32 v122, v122
    v_mfma_f32_16x16x32_bf16 v[172:175], a[196:199], a[32:35], v[172:175]
    ds_read_b128 v[192:195], v51 offset:0
    v_rcp_f32 v123, v123
    v_mfma_f32_16x16x32_bf16 v[176:179], a[180:183], a[4:7], 0
    ds_read_b128 v[196:199], v51 offset:1280
    v_rcp_f32 v128, v128
    v_mfma_f32_16x16x32_bf16 v[176:179], a[184:187], a[12:15], v[176:179]
    buffer_load_dwordx4 v1, s[8:11], s96 offen offset:1024 sc1 lds
    ds_read_b128 v[200:203], v51 offset:2560
    v_mul_f32 v122, v122, v138
    v_mfma_f32_16x16x32_bf16 v[176:179], a[188:191], a[20:23], v[176:179]
    ds_read_b128 v[204:207], v51 offset:3840
    v_rcp_f32 v129, v129
    v_mfma_f32_16x16x32_bf16 v[176:179], a[192:195], a[28:31], v[176:179]
    ds_read_b128 v[208:211], v51 offset:5120
    v_mul_f32 v123, v123, v139
    v_cvt_pk_bf16_f32 v137, v122, v123
    v_mfma_f32_16x16x32_bf16 v[176:179], a[196:199], a[36:39], v[176:179]
    ds_read_b128 a[180:183], v2 offset:1024
    v_mul_f32 v128, v128, v144
    s_waitcnt lgkmcnt(6)
    v_mfma_f32_16x16x32_bf16 v[148:151], a[160:163], a[40:43], v[148:151]
    ds_read_b128 a[184:187], v2 offset:5120
    buffer_load_dwordx4 v1, s[8:11], s96 offen offset:2048 sc1 lds
    v_mul_f32 v129, v129, v145
    v_mfma_f32_16x16x32_bf16 v[148:151], a[164:167], a[48:51], v[148:151]
    ds_read_b128 a[188:191], v2 offset:9216
    v_cvt_pk_bf16_f32 v138, v128, v129
    v_mul_f32 v131, 0xbfb8aa3b, v131
    v_mfma_f32_16x16x32_bf16 v[148:151], a[168:171], a[56:59], v[148:151]
    ds_read_b128 a[192:195], v2 offset:13312
    v_exp_f32 v130, v130
    v_mfma_f32_16x16x32_bf16 v[148:151], a[172:175], a[64:67], v[148:151]
    ds_read_b128 a[196:199], v2 offset:17408
    v_exp_f32 v131, v131
    v_mfma_f32_16x16x32_bf16 v[148:151], a[176:179], a[72:75], v[148:151]
    buffer_load_dwordx4 v1, s[8:11], s96 offen offset:3072 sc1 lds
    s_add_u32 m0, s45, 24576
    v_add_f32 v130, 1.0, v130
    v_mfma_f32_16x16x32_bf16 v[152:155], a[160:163], a[44:47], v[152:155]
    s_waitcnt lgkmcnt(9)
    v_add_f32 v192, v192, v193
    v_add_f32 v131, 1.0, v131
    v_mfma_f32_16x16x32_bf16 v[152:155], a[164:167], a[52:55], v[152:155]
    s_waitcnt lgkmcnt(8)
    v_add_f32 v196, v196, v197
    v_mfma_f32_16x16x32_bf16 v[152:155], a[168:171], a[60:63], v[152:155]
    s_waitcnt lgkmcnt(7)
    v_add_f32 v200, v200, v201
    v_mfma_f32_16x16x32_bf16 v[152:155], a[172:175], a[68:71], v[152:155]
    buffer_load_dwordx4 v4, s[8:11], s96 offen sc1 lds
    s_waitcnt lgkmcnt(6)
    v_add_f32 v204, v204, v205
    v_mfma_f32_16x16x32_bf16 v[152:155], a[176:179], a[76:79], v[152:155]
    ds_read_b128 a[160:163], v2 offset:2048
    s_waitcnt lgkmcnt(1)
    v_mfma_f32_16x16x32_bf16 v[156:159], a[180:183], a[40:43], v[156:159]
    ds_read_b128 a[164:167], v2 offset:6144
    v_add_f32 v208, v208, v209
    v_add_f32 v192, v192, v194
    v_mfma_f32_16x16x32_bf16 v[156:159], a[184:187], a[48:51], v[156:159]
    ds_read_b128 a[168:171], v2 offset:10240
    v_add_f32 v196, v196, v198
    v_add_f32 v200, v200, v202
    v_mfma_f32_16x16x32_bf16 v[156:159], a[188:191], a[56:59], v[156:159]
    ds_read_b128 a[172:175], v2 offset:14336
    v_add_f32 v204, v204, v206
    v_add_f32 v208, v208, v210
    v_mfma_f32_16x16x32_bf16 v[156:159], a[192:195], a[64:67], v[156:159]
    ds_read_b128 a[176:179], v2 offset:18432
    v_fmac_f32 v180, v52, v192
    v_fmac_f32 v181, v53, v196
    v_mfma_f32_16x16x32_bf16 v[156:159], a[196:199], a[72:75], v[156:159]
    v_fmac_f32 v182, v54, v200
    v_fmac_f32 v183, v55, v204
    v_fmac_f32 v184, v56, v208
    v_mfma_f32_16x16x32_bf16 v[160:163], a[180:183], a[44:47], v[160:163]
    v_fmac_f32_dpp v180, v192, v57 quad_perm:[1,0,3,2] row_mask:0xf bank_mask:0xf
    v_fmac_f32_dpp v181, v196, v58 quad_perm:[1,0,3,2] row_mask:0xf bank_mask:0xf
    v_fmac_f32_dpp v182, v200, v59 quad_perm:[1,0,3,2] row_mask:0xf bank_mask:0xf
    v_mfma_f32_16x16x32_bf16 v[160:163], a[184:187], a[52:55], v[160:163]
    v_fmac_f32_dpp v183, v204, v60 quad_perm:[1,0,3,2] row_mask:0xf bank_mask:0xf
    v_fmac_f32_dpp v184, v208, v61 quad_perm:[1,0,3,2] row_mask:0xf bank_mask:0xf
    s_mul_i32 s61, s38, 256
    s_add_u32 s61, s61, s46
    v_mfma_f32_16x16x32_bf16 v[160:163], a[188:191], a[60:63], v[160:163]
    v_add_u32 v50, 5120, v1
    v_add_u32 v51, 90112, v1
    s_cmp_eq_u32 s41, 0
    s_cselect_b64 s[54:55], -1, 0
    v_cndmask_b32 v52, v1, v5, s[54:55]
    v_cndmask_b32 v53, v1, v6, s[54:55]
    v_cndmask_b32 v54, v1, v7, s[54:55]
    v_cndmask_b32 v55, v1, v8, s[54:55]
    v_cndmask_b32 v56, v4, v9, s[54:55]
    v_mfma_f32_16x16x32_bf16 v[160:163], a[192:195], a[68:71], v[160:163]
    s_cmp_eq_u32 s41, 0
    s_cselect_b64 s[54:55], -1, 0
    v_cndmask_b32 v59, v1, v12, s[54:55]
    v_cndmask_b32 v60, v50, v13, s[54:55]
    v_cndmask_b32 v57, v51, v1, s[54:55]
    v_cndmask_b32 v58, v1, v51, s[54:55]
    v_mfma_f32_16x16x32_bf16 v[160:163], a[196:199], a[76:79], v[160:163]
    ds_read_b128 a[180:183], v2 offset:3072
    v_fmac_f32 v75, v22, v180
    s_waitcnt lgkmcnt(1)
    v_mfma_f32_16x16x32_bf16 v[164:167], a[160:163], a[40:43], v[164:167]
    ds_read_b128 a[184:187], v2 offset:7168
    s_barrier
    v_mfma_f32_16x16x32_bf16 v[164:167], a[164:167], a[48:51], v[164:167]
    ds_read_b128 a[188:191], v2 offset:11264
    s_add_u32 m0, s45, 40960
    v_fmac_f32_dpp v75, -v180, v27 quad_perm:[1,0,3,2] row_mask:0xf bank_mask:0xf
    v_mfma_f32_16x16x32_bf16 v[164:167], a[168:171], a[56:59], v[164:167]
    ds_read_b128 a[192:195], v2 offset:15360
    s_add_u32 s96, s44, 225280
    v_fmac_f32 v76, v22, v75
    v_mfma_f32_16x16x32_bf16 v[164:167], a[172:175], a[64:67], v[164:167]
    ds_read_b128 a[196:199], v2 offset:19456
    buffer_load_dwordx4 v1, s[8:11], s96 offen sc1 lds
    v_fmac_f32_dpp v76, -v75, v27 quad_perm:[1,0,3,2] row_mask:0xf bank_mask:0xf
    v_mfma_f32_16x16x32_bf16 v[164:167], a[176:179], a[72:75], v[164:167]
    v_fmac_f32 v77, v22, v76
    v_fmac_f32_dpp v77, -v76, v27 quad_perm:[1,0,3,2] row_mask:0xf bank_mask:0xf
    v_fmac_f32 v78, v22, v77
    v_mfma_f32_16x16x32_bf16 v[168:171], a[160:163], a[44:47], v[168:171]
    v_fmac_f32_dpp v78, -v77, v27 quad_perm:[1,0,3,2] row_mask:0xf bank_mask:0xf
    v_fmac_f32 v79, v22, v78
    v_fmac_f32 v83, v23, v181
    v_mfma_f32_16x16x32_bf16 v[168:171], a[164:167], a[52:55], v[168:171]
    v_fmac_f32_dpp v79, -v78, v27 quad_perm:[1,0,3,2] row_mask:0xf bank_mask:0xf
    v_fmac_f32 v80, v22, v79
    v_fmac_f32_dpp v83, -v181, v28 quad_perm:[1,0,3,2] row_mask:0xf bank_mask:0xf
    v_mfma_f32_16x16x32_bf16 v[168:171], a[168:171], a[60:63], v[168:171]
    buffer_load_dwordx4 v1, s[8:11], s96 offen offset:1024 sc1 lds
    v_fmac_f32_dpp v80, -v79, v27 quad_perm:[1,0,3,2] row_mask:0xf bank_mask:0xf
    v_fmac_f32 v81, v22, v80
    v_mfma_f32_16x16x32_bf16 v[168:171], a[172:175], a[68:71], v[168:171]
    v_fmac_f32_dpp v81, -v80, v27 quad_perm:[1,0,3,2] row_mask:0xf bank_mask:0xf
    v_fmac_f32 v82, v22, v81
    v_fmac_f32 v84, v23, v83
    v_mfma_f32_16x16x32_bf16 v[168:171], a[176:179], a[76:79], v[168:171]
    ds_read_b128 a[160:163], v2 offset:20480
    v_fmac_f32_dpp v82, -v81, v27 quad_perm:[1,0,3,2] row_mask:0xf bank_mask:0xf
    s_waitcnt lgkmcnt(1)
    v_mfma_f32_16x16x32_bf16 v[172:175], a[180:183], a[40:43], v[172:175]
    ds_read_b128 a[164:167], v2 offset:24576
    v_cvt_pk_bf16_f32 v192, v75, v76
    v_cvt_pk_bf16_f32 v193, v77, v78
    v_mfma_f32_16x16x32_bf16 v[172:175], a[184:187], a[48:51], v[172:175]
    ds_read_b128 a[168:171], v2 offset:28672
    buffer_load_dwordx4 v1, s[8:11], s96 offen offset:2048 sc1 lds
    v_cvt_pk_bf16_f32 v194, v79, v80
    v_mfma_f32_16x16x32_bf16 v[172:175], a[188:191], a[56:59], v[172:175]
    ds_read_b128 a[172:175], v2 offset:32768
    v_cvt_pk_bf16_f32 v195, v81, v82
    v_fmac_f32_dpp v84, -v83, v28 quad_perm:[1,0,3,2] row_mask:0xf bank_mask:0xf
    v_mfma_f32_16x16x32_bf16 v[172:175], a[192:195], a[64:67], v[172:175]
    ds_read_b128 a[176:179], v2 offset:36864
    v_fmac_f32 v85, v23, v84
    v_fmac_f32_dpp v85, -v84, v28 quad_perm:[1,0,3,2] row_mask:0xf bank_mask:0xf
    v_mfma_f32_16x16x32_bf16 v[172:175], a[196:199], a[72:75], v[172:175]
    ds_write_b64 v64, v[192:193] offset:0
    v_fmac_f32 v86, v23, v85
    v_fmac_f32_dpp v86, -v85, v28 quad_perm:[1,0,3,2] row_mask:0xf bank_mask:0xf
    v_mfma_f32_16x16x32_bf16 v[176:179], a[180:183], a[44:47], v[176:179]
    buffer_load_dwordx4 v1, s[8:11], s96 offen offset:3072 sc1 lds
    s_add_u32 m0, s45, 45056
    v_fmac_f32 v87, v23, v86
    v_mfma_f32_16x16x32_bf16 v[176:179], a[184:187], a[52:55], v[176:179]
    ds_write_b64 v64, v[194:195] offset:2560
    v_fmac_f32_dpp v87, -v86, v28 quad_perm:[1,0,3,2] row_mask:0xf bank_mask:0xf
    v_fmac_f32 v88, v23, v87
    v_mfma_f32_16x16x32_bf16 v[176:179], a[188:191], a[60:63], v[176:179]
    v_fmac_f32_dpp v88, -v87, v28 quad_perm:[1,0,3,2] row_mask:0xf bank_mask:0xf
    v_fmac_f32 v89, v23, v88
    v_fmac_f32 v91, v24, v182
    v_mfma_f32_16x16x32_bf16 v[176:179], a[192:195], a[68:71], v[176:179]
    ds_read_b64_tr_b16 v[192:193], v65 offset:0
    v_fmac_f32_dpp v89, -v88, v28 quad_perm:[1,0,3,2] row_mask:0xf bank_mask:0xf
    v_fmac_f32 v90, v23, v89
    v_mfma_f32_16x16x32_bf16 v[176:179], a[196:199], a[76:79], v[176:179]
    ds_read_b128 a[180:183], v2 offset:21504
    v_fmac_f32_dpp v90, -v89, v28 quad_perm:[1,0,3,2] row_mask:0xf bank_mask:0xf
    s_waitcnt lgkmcnt(4)
    v_mfma_f32_16x16x32_bf16 v[148:151], a[160:163], a[80:83], v[148:151]
    ds_read_b128 a[184:187], v2 offset:25600
    buffer_load_dwordx4 v4, s[8:11], s96 offen sc1 lds
    v_cvt_pk_bf16_f32 v196, v83, v84
    v_mfma_f32_16x16x32_bf16 v[148:151], a[164:167], a[88:91], v[148:151]
    ds_read_b128 a[188:191], v2 offset:29696
    s_mov_b32 s0, 321536
    v_cvt_pk_bf16_f32 v197, v85, v86
    v_mfma_f32_16x16x32_bf16 v[148:151], a[168:171], a[96:99], v[148:151]
    ds_read_b128 a[192:195], v2 offset:33792
    v_cvt_pk_bf16_f32 v198, v87, v88
    v_cvt_pk_bf16_f32 v199, v89, v90
    v_mfma_f32_16x16x32_bf16 v[148:151], a[172:175], a[104:107], v[148:151]
    ds_read_b128 a[196:199], v2 offset:37888
    buffer_load_dwordx4 v[212:215], v1, s[8:11], s0 offen offset:0 sc1
    v_fmac_f32_dpp v91, -v182, v29 quad_perm:[1,0,3,2] row_mask:0xf bank_mask:0xf
    v_mfma_f32_16x16x32_bf16 v[148:151], a[176:179], a[112:115], v[148:151]
    ds_read_b64_tr_b16 v[194:195], v66 offset:256
    v_rcp_f32 v130, v130
    v_mfma_f32_16x16x32_bf16 v[152:155], a[160:163], a[84:87], v[152:155]
    ds_write_b64 v64, v[196:197] offset:512
    v_rcp_f32 v131, v131
    v_mfma_f32_16x16x32_bf16 v[152:155], a[164:167], a[92:95], v[152:155]
    v_mul_f32 v130, v130, v146
    v_mul_f32 v131, v131, v147
    v_cvt_pk_bf16_f32 v139, v130, v131
    v_mfma_f32_16x16x32_bf16 v[152:155], a[168:171], a[100:103], v[152:155]
    ds_write_b64 v64, v[198:199] offset:3072
    s_add_u32 s53, s3, 131072
    buffer_store_dwordx4 v[136:139], v1, s[8:11], s53 offen sc1
    v_mfma_f32_16x16x32_bf16 v[152:155], a[172:175], a[108:111], v[152:155]
    v_fmac_f32 v92, v24, v91
    v_fmac_f32_dpp v92, -v91, v29 quad_perm:[1,0,3,2] row_mask:0xf bank_mask:0xf
    v_fmac_f32 v93, v24, v92
    v_mfma_f32_16x16x32_bf16 v[152:155], a[176:179], a[116:119], v[152:155]
    ds_read_b128 a[160:163], v2 offset:22528
    v_fmac_f32_dpp v93, -v92, v29 quad_perm:[1,0,3,2] row_mask:0xf bank_mask:0xf
    s_waitcnt lgkmcnt(4)
    v_mfma_f32_16x16x32_bf16 v[156:159], a[180:183], a[80:83], v[156:159]
    ds_read_b128 a[164:167], v2 offset:26624
    v_fmac_f32 v94, v24, v93
    v_fmac_f32_dpp v94, -v93, v29 quad_perm:[1,0,3,2] row_mask:0xf bank_mask:0xf
    v_mfma_f32_16x16x32_bf16 v[156:159], a[184:187], a[88:91], v[156:159]
    ds_read_b128 a[168:171], v2 offset:30720
    v_fmac_f32 v95, v24, v94
    v_fmac_f32_dpp v95, -v94, v29 quad_perm:[1,0,3,2] row_mask:0xf bank_mask:0xf
    v_mfma_f32_16x16x32_bf16 v[156:159], a[188:191], a[96:99], v[156:159]
    ds_read_b128 a[172:175], v2 offset:34816
    v_fmac_f32 v96, v24, v95
    v_fmac_f32_dpp v96, -v95, v29 quad_perm:[1,0,3,2] row_mask:0xf bank_mask:0xf
    v_mfma_f32_16x16x32_bf16 v[156:159], a[192:195], a[104:107], v[156:159]
    ds_read_b128 a[176:179], v2 offset:38912
    v_fmac_f32 v97, v24, v96
    v_fmac_f32_dpp v97, -v96, v29 quad_perm:[1,0,3,2] row_mask:0xf bank_mask:0xf
    v_mfma_f32_16x16x32_bf16 v[156:159], a[196:199], a[112:115], v[156:159]
    s_waitcnt lgkmcnt(7)
    buffer_store_dwordx4 v[192:195], v67, s[8:11], s61 offen offset:0 sc1
    s_add_u32 s61, s61, 4096
    v_mfma_f32_16x16x32_bf16 v[160:163], a[180:183], a[84:87], v[160:163]
    ds_read_b64_tr_b16 v[196:197], v65 offset:512
    v_fmac_f32 v98, v24, v97
    v_fmac_f32_dpp v98, -v97, v29 quad_perm:[1,0,3,2] row_mask:0xf bank_mask:0xf
    v_mfma_f32_16x16x32_bf16 v[160:163], a[184:187], a[92:95], v[160:163]
    ds_read_b64_tr_b16 v[198:199], v66 offset:768
    v_cvt_pk_bf16_f32 v200, v91, v92
    v_cvt_pk_bf16_f32 v201, v93, v94
    v_mfma_f32_16x16x32_bf16 v[160:163], a[188:191], a[100:103], v[160:163]
    v_cvt_pk_bf16_f32 v202, v95, v96
    v_cvt_pk_bf16_f32 v203, v97, v98
    ds_write_b64 v64, v[200:201] offset:1024
    v_mfma_f32_16x16x32_bf16 v[160:163], a[192:195], a[108:111], v[160:163]
    v_fmac_f32 v99, v25, v183
    v_fmac_f32_dpp v99, -v183, v30 quad_perm:[1,0,3,2] row_mask:0xf bank_mask:0xf
    v_fmac_f32 v100, v25, v99
    v_mfma_f32_16x16x32_bf16 v[160:163], a[196:199], a[116:119], v[160:163]
    ds_read_b128 a[180:183], v2 offset:23552
    v_fmac_f32_dpp v100, -v99, v30 quad_perm:[1,0,3,2] row_mask:0xf bank_mask:0xf
    s_waitcnt lgkmcnt(4)
    v_mfma_f32_16x16x32_bf16 v[164:167], a[160:163], a[80:83], v[164:167]
    ds_read_b128 a[184:187], v2 offset:27648
    v_fmac_f32 v101, v25, v100
    v_fmac_f32_dpp v101, -v100, v30 quad_perm:[1,0,3,2] row_mask:0xf bank_mask:0xf
    v_mfma_f32_16x16x32_bf16 v[164:167], a[164:167], a[88:91], v[164:167]
    ds_read_b128 a[188:191], v2 offset:31744
    v_fmac_f32 v102, v25, v101
    v_fmac_f32_dpp v102, -v101, v30 quad_perm:[1,0,3,2] row_mask:0xf bank_mask:0xf
    v_mfma_f32_16x16x32_bf16 v[164:167], a[168:171], a[96:99], v[164:167]
    ds_read_b128 a[192:195], v2 offset:35840
    v_fmac_f32 v103, v25, v102
    v_fmac_f32_dpp v103, -v102, v30 quad_perm:[1,0,3,2] row_mask:0xf bank_mask:0xf
    v_mfma_f32_16x16x32_bf16 v[164:167], a[172:175], a[104:107], v[164:167]
    ds_read_b128 a[196:199], v2 offset:39936
    v_fmac_f32 v104, v25, v103
    v_fmac_f32_dpp v104, -v103, v30 quad_perm:[1,0,3,2] row_mask:0xf bank_mask:0xf
    v_mfma_f32_16x16x32_bf16 v[164:167], a[176:179], a[112:115], v[164:167]
    s_waitcnt lgkmcnt(6)
    buffer_store_dwordx4 v[196:199], v67, s[8:11], s61 offen offset:0 sc1
    s_add_u32 s61, s61, 4096
    v_mfma_f32_16x16x32_bf16 v[168:171], a[160:163], a[84:87], v[168:171]
    ds_write_b64 v64, v[202:203] offset:3584
    v_fmac_f32 v105, v25, v104
    v_fmac_f32_dpp v105, -v104, v30 quad_perm:[1,0,3,2] row_mask:0xf bank_mask:0xf
    v_mfma_f32_16x16x32_bf16 v[168:171], a[164:167], a[92:95], v[168:171]
    v_fmac_f32 v106, v25, v105
    v_fmac_f32_dpp v106, -v105, v30 quad_perm:[1,0,3,2] row_mask:0xf bank_mask:0xf
    v_cvt_pk_bf16_f32 v204, v99, v100
    v_mfma_f32_16x16x32_bf16 v[168:171], a[168:171], a[100:103], v[168:171]
    ds_read_b64_tr_b16 v[200:201], v65 offset:1024
    v_cvt_pk_bf16_f32 v205, v101, v102
    v_cvt_pk_bf16_f32 v206, v103, v104
    v_mfma_f32_16x16x32_bf16 v[168:171], a[172:175], a[108:111], v[168:171]
    ds_read_b64_tr_b16 v[202:203], v66 offset:1280
    v_cvt_pk_bf16_f32 v207, v105, v106
    v_fmac_f32 v107, v26, v184
    v_mfma_f32_16x16x32_bf16 v[168:171], a[176:179], a[116:119], v[168:171]
    s_barrier
    ds_read_b128 a[160:163], v2 offset:40960
    s_waitcnt lgkmcnt(4)
    v_mfma_f32_16x16x32_bf16 v[172:175], a[180:183], a[80:83], v[172:175]
    ds_read_b128 a[164:167], v2 offset:45056
    v_fmac_f32_dpp v107, -v184, v31 quad_perm:[1,0,3,2] row_mask:0xf bank_mask:0xf
    v_fmac_f32 v108, v26, v107
    v_mfma_f32_16x16x32_bf16 v[172:175], a[184:187], a[88:91], v[172:175]
    ds_read_b128 a[168:171], v2 offset:49152
    v_fmac_f32_dpp v108, -v107, v31 quad_perm:[1,0,3,2] row_mask:0xf bank_mask:0xf
    v_fmac_f32 v109, v26, v108
    v_mfma_f32_16x16x32_bf16 v[172:175], a[188:191], a[96:99], v[172:175]
    ds_read_b128 a[172:175], v2 offset:53248
    v_fmac_f32_dpp v109, -v108, v31 quad_perm:[1,0,3,2] row_mask:0xf bank_mask:0xf
    v_fmac_f32 v110, v26, v109
    v_mfma_f32_16x16x32_bf16 v[172:175], a[192:195], a[104:107], v[172:175]
    ds_read_b128 a[176:179], v2 offset:57344
    s_waitcnt vmcnt(3)
    v_bitop3_b32 v212, v212, v213, s42 bitop3:126
    v_mfma_f32_16x16x32_bf16 v[172:175], a[196:199], a[112:115], v[172:175]
    v_bitop3_b32 v212, v212, v214, s42 bitop3:246
    v_bitop3_b32 v212, v212, v215, s42 bitop3:246
    v_cmp_ne_u32 vcc, 0, v212
    s_cbranch_vccnz L_slow3
L_ok3:
    v_mfma_f32_16x16x32_bf16 v[176:179], a[180:183], a[84:87], v[176:179]
    s_add_u32 m0, s45, 61440
    s_nop 0
    buffer_load_dwordx4 v52, s[20:23], s64 offen sc1 lds
    v_mfma_f32_16x16x32_bf16 v[176:179], a[184:187], a[92:95], v[176:179]
    s_lshl_b32 s50, s2, 2
    s_add_u32 s50, s50, s36
    s_cmp_eq_u32 s50, 0
    s_cselect_b32 s50, 0, 2146435072
    buffer_store_dword v21, v18, s[8:11], s50 offen sc1
    v_mfma_f32_16x16x32_bf16 v[176:179], a[188:191], a[100:103], v[176:179]
    ds_write_b64 v64, v[204:205] offset:1536
    v_fmac_f32_dpp v110, -v109, v31 quad_perm:[1,0,3,2] row_mask:0xf bank_mask:0xf
    v_fmac_f32 v111, v26, v110
    v_mfma_f32_16x16x32_bf16 v[176:179], a[192:195], a[108:111], v[176:179]
    s_waitcnt lgkmcnt(6)
    buffer_store_dwordx4 v[200:203], v67, s[8:11], s61 offen offset:0 sc1
    s_add_u32 s61, s61, 4096
    v_mfma_f32_16x16x32_bf16 v[176:179], a[196:199], a[116:119], v[176:179]
    ds_read_b128 a[180:183], v2 offset:41984
    v_fmac_f32_dpp v111, -v110, v31 quad_perm:[1,0,3,2] row_mask:0xf bank_mask:0xf
    s_waitcnt lgkmcnt(2)
    v_mfma_f32_16x16x32_bf16 v[148:151], a[160:163], a[120:123], v[148:151]
    ds_read_b128 a[184:187], v2 offset:46080
    v_fmac_f32 v112, v26, v111
    v_fmac_f32_dpp v112, -v111, v31 quad_perm:[1,0,3,2] row_mask:0xf bank_mask:0xf
    v_mfma_f32_16x16x32_bf16 v[148:151], a[164:167], a[128:131], v[148:151]
    ds_read_b128 a[188:191], v2 offset:50176
    buffer_load_dwordx2 v[246:247], v73, s[8:11], s98 offen offset:0 sc1
    v_mfma_f32_16x16x32_bf16 v[148:151], a[168:171], a[136:139], v[148:151]
    ds_read_b128 a[192:195], v2 offset:54272
    v_fmac_f32 v113, v26, v112
    v_mfma_f32_16x16x32_bf16 v[148:151], a[172:175], a[144:147], v[148:151]
    ds_read_b128 a[196:199], v2 offset:58368
    v_fmac_f32_dpp v113, -v112, v31 quad_perm:[1,0,3,2] row_mask:0xf bank_mask:0xf
    v_mfma_f32_16x16x32_bf16 v[148:151], a[176:179], a[152:155], v[148:151]
    ds_write_b64 v64, v[206:207] offset:4096
    v_fmac_f32 v114, v26, v113
    v_fmac_f32_dpp v114, -v113, v31 quad_perm:[1,0,3,2] row_mask:0xf bank_mask:0xf
    v_mfma_f32_16x16x32_bf16 v[152:155], a[160:163], a[124:127], v[152:155]
    buffer_load_dwordx4 v53, s[20:23], s64 offen offset:1024 sc1 lds
    v_cvt_pk_bf16_f32 v208, v107, v108
    v_mfma_f32_16x16x32_bf16 v[152:155], a[164:167], a[132:135], v[152:155]
    ds_read_b64_tr_b16 v[204:205], v65 offset:1536
    v_cvt_pk_bf16_f32 v209, v109, v110
    v_mfma_f32_16x16x32_bf16 v[152:155], a[168:171], a[140:143], v[152:155]
    ds_read_b64_tr_b16 v[206:207], v66 offset:1792
    v_cvt_pk_bf16_f32 v210, v111, v112
    v_mfma_f32_16x16x32_bf16 v[152:155], a[172:175], a[148:151], v[152:155]
    v_cvt_pk_bf16_f32 v211, v113, v114
    ds_write_b64 v64, v[208:209] offset:2048
    v_mul_f32 v148, 0xbfb8aa3b, v148
    v_mfma_f32_16x16x32_bf16 v[152:155], a[176:179], a[156:159], v[152:155]
    ds_read_b128 a[160:163], v2 offset:43008
    s_waitcnt lgkmcnt(5)
    v_mfma_f32_16x16x32_bf16 v[156:159], a[180:183], a[120:123], v[156:159]
    ds_read_b128 a[164:167], v2 offset:47104
    buffer_load_dwordx2 v[248:249], v73, s[8:11], s100 offen offset:512 sc1
    v_mfma_f32_16x16x32_bf16 v[156:159], a[184:187], a[128:131], v[156:159]
    ds_read_b128 a[168:171], v2 offset:51200
    v_mul_f32 v149, 0xbfb8aa3b, v149
    v_mfma_f32_16x16x32_bf16 v[156:159], a[188:191], a[136:139], v[156:159]
    ds_read_b128 a[172:175], v2 offset:55296
    v_exp_f32 v148, v148
    v_mfma_f32_16x16x32_bf16 v[156:159], a[192:195], a[144:147], v[156:159]
    ds_read_b128 a[176:179], v2 offset:59392
    buffer_load_dwordx4 v54, s[20:23], s64 offen offset:2048 sc1 lds
    v_mfma_f32_16x16x32_bf16 v[156:159], a[196:199], a[152:155], v[156:159]
L_pad3:
    s_cbranch_execz L_back
    ds_write_b64 v64, v[210:211] offset:4608
    v_mul_f32 v150, 0xbfb8aa3b, v150
    v_mfma_f32_16x16x32_bf16 v[160:163], a[180:183], a[124:127], v[160:163]
    v_exp_f32 v149, v149
    v_mfma_f32_16x16x32_bf16 v[160:163], a[184:187], a[132:135], v[160:163]
    ds_read_b64_tr_b16 v[208:209], v65 offset:2048
    v_add_f32 v148, 1.0, v148
    v_add_f32 v149, 1.0, v149
    v_mfma_f32_16x16x32_bf16 v[160:163], a[188:191], a[140:143], v[160:163]
    s_waitcnt lgkmcnt(8)
    buffer_store_dwordx4 v[204:207], v67, s[8:11], s61 offen offset:0 sc1
    v_mfma_f32_16x16x32_bf16 v[160:163], a[192:195], a[148:151], v[160:163]
    s_add_u32 s61, s61, 4096
    ds_read_b64_tr_b16 v[210:211], v66 offset:2304
    v_mfma_f32_16x16x32_bf16 v[160:163], a[196:199], a[156:159], v[160:163]
    ds_read_b128 a[180:183], v2 offset:44032
    s_waitcnt lgkmcnt(4)
    v_mfma_f32_16x16x32_bf16 v[164:167], a[160:163], a[120:123], v[164:167]
    ds_read_b128 a[184:187], v2 offset:48128
    v_rcp_f32 v148, v148
    v_mfma_f32_16x16x32_bf16 v[164:167], a[164:167], a[128:131], v[164:167]
    ds_read_b128 a[188:191], v2 offset:52224
    buffer_load_dwordx2 v[250:251], v73, s[8:11], s98 offen offset:2048 sc1
    v_mfma_f32_16x16x32_bf16 v[164:167], a[168:171], a[136:139], v[164:167]
    ds_read_b128 a[192:195], v2 offset:56320
    v_mul_f32 v151, 0xbfb8aa3b, v151
    v_mfma_f32_16x16x32_bf16 v[164:167], a[172:175], a[144:147], v[164:167]
    ds_read_b128 a[196:199], v2 offset:60416
    v_mul_f32 v156, 0xbfb8aa3b, v156
    v_mfma_f32_16x16x32_bf16 v[164:167], a[176:179], a[152:155], v[164:167]
    v_rcp_f32 v149, v149
    v_mul_f32 v157, 0xbfb8aa3b, v157
    v_mfma_f32_16x16x32_bf16 v[168:171], a[160:163], a[124:127], v[168:171]
    buffer_load_dwordx4 v55, s[20:23], s64 offen offset:3072 sc1 lds
    s_add_u32 m0, s45, 65536
    v_mfma_f32_16x16x32_bf16 v[168:171], a[164:167], a[132:135], v[168:171]
    v_exp_f32 v150, v150
    v_mfma_f32_16x16x32_bf16 v[168:171], a[168:171], a[140:143], v[168:171]
    v_exp_f32 v151, v151
    v_mfma_f32_16x16x32_bf16 v[168:171], a[172:175], a[148:151], v[168:171]
    v_exp_f32 v156, v156
    v_add_f32 v150, 1.0, v150
    v_mfma_f32_16x16x32_bf16 v[168:171], a[176:179], a[156:159], v[168:171]
    s_barrier
    ds_read_b128 a[160:163], v3 offset:0
    s_waitcnt lgkmcnt(1)
    v_mfma_f32_16x16x32_bf16 v[172:175], a[180:183], a[120:123], v[172:175]
    ds_read_b128 a[164:167], v3 offset:4096
    s_waitcnt vmcnt(10)
    s_barrier
    v_mfma_f32_16x16x32_bf16 v[172:175], a[184:187], a[128:131], v[172:175]
    ds_read_b128 a[168:171], v3 offset:8192
    s_add_u32 s53, s56, 69632
    buffer_store_dword v21, v18, s[8:11], s53 offen sc1
    v_mfma_f32_16x16x32_bf16 v[172:175], a[188:191], a[136:139], v[172:175]
    ds_read_b128 a[172:175], v3 offset:12288
    v_exp_f32 v157, v157
    v_mfma_f32_16x16x32_bf16 v[172:175], a[192:195], a[144:147], v[172:175]
    ds_read_b128 a[176:179], v3 offset:16384
    buffer_store_dwordx4 v[208:211], v67, s[8:11], s61 offen offset:0 sc1
    v_mfma_f32_16x16x32_bf16 v[172:175], a[196:199], a[152:155], v[172:175]
    v_add_f32 v151, 1.0, v151
    v_add_f32 v156, 1.0, v156
    v_mfma_f32_16x16x32_bf16 v[176:179], a[180:183], a[124:127], v[176:179]
    v_rcp_f32 v150, v150
    v_mfma_f32_16x16x32_bf16 v[176:179], a[184:187], a[132:135], v[176:179]
    v_rcp_f32 v151, v151
    v_add_f32 v157, 1.0, v157
    v_mfma_f32_16x16x32_bf16 v[176:179], a[188:191], a[140:143], v[176:179]
    buffer_load_dwordx2 v[252:253], v73, s[8:11], s100 offen offset:2560 sc1
    v_mul_f32 v158, 0xbfb8aa3b, v158
    v_mfma_f32_16x16x32_bf16 v[176:179], a[192:195], a[148:151], v[176:179]
    v_rcp_f32 v156, v156
    v_mfma_f32_16x16x32_bf16 v[176:179], a[196:199], a[156:159], v[176:179]
    ds_read_b128 a[180:183], v3 offset:1024
    s_waitcnt lgkmcnt(1)
    v_mfma_f32_16x16x32_bf16 v[116:119], a[160:163], a[0:3], 0
    ds_read_b128 a[184:187], v3 offset:5120
    buffer_load_dwordx4 v56, s[20:23], s64 offen sc1 lds
    v_mul_f32 v148, v148, v164
    v_mfma_f32_16x16x32_bf16 v[116:119], a[164:167], a[8:11], v[116:119]
    ds_read_b128 a[188:191], v3 offset:9216
    s_add_u32 m0, s45, 81920
    v_mfma_f32_16x16x32_bf16 v[116:119], a[168:171], a[16:19], v[116:119]
    ds_read_b128 a[192:195], v3 offset:13312
    v_mul_f32 v149, v149, v165
    v_mfma_f32_16x16x32_bf16 v[116:119], a[172:175], a[24:27], v[116:119]
    ds_read_b128 a[196:199], v3 offset:17408
    v_cvt_pk_bf16_f32 v164, v148, v149
    v_mfma_f32_16x16x32_bf16 v[116:119], a[176:179], a[32:35], v[116:119]
    buffer_load_dwordx2 v[254:255], v73, s[8:11], s101 offen offset:0 sc1
    v_rcp_f32 v157, v157
    v_mfma_f32_16x16x32_bf16 v[120:123], a[160:163], a[4:7], 0
    v_mul_f32 v150, v150, v166
    v_mul_f32 v151, v151, v167
    v_mfma_f32_16x16x32_bf16 v[120:123], a[164:167], a[12:15], v[120:123]
    v_cvt_pk_bf16_f32 v165, v150, v151
    v_mul_f32 v156, v156, v172
    v_mfma_f32_16x16x32_bf16 v[120:123], a[168:171], a[20:23], v[120:123]
    buffer_load_dwordx4 v52, s[20:23], s65 offen sc1 lds
    v_mul_f32 v157, v157, v173
    v_mfma_f32_16x16x32_bf16 v[120:123], a[172:175], a[28:31], v[120:123]
    v_cvt_pk_bf16_f32 v166, v156, v157
    v_mul_f32 v159, 0xbfb8aa3b, v159
    v_mul_f32 v152, 0xbfb8aa3b, v152
    v_mfma_f32_16x16x32_bf16 v[120:123], a[176:179], a[36:39], v[120:123]
    ds_read_b128 a[160:163], v3 offset:2048
    s_waitcnt lgkmcnt(1)
    v_mfma_f32_16x16x32_bf16 v[124:127], a[180:183], a[0:3], 0
    ds_read_b128 a[164:167], v3 offset:6144
    v_mul_f32 v153, 0xbfb8aa3b, v153
    v_mfma_f32_16x16x32_bf16 v[124:127], a[184:187], a[8:11], v[124:127]
    ds_read_b128 a[168:171], v3 offset:10240
    buffer_load_dwordx4 v53, s[20:23], s65 offen offset:1024 sc1 lds
    v_mfma_f32_16x16x32_bf16 v[124:127], a[188:191], a[16:19], v[124:127]
    ds_read_b128 a[172:175], v3 offset:14336
    v_exp_f32 v158, v158
    v_mfma_f32_16x16x32_bf16 v[124:127], a[192:195], a[24:27], v[124:127]
    ds_read_b128 a[176:179], v3 offset:18432
    v_mul_f32 v154, 0xbfb8aa3b, v154
    v_mfma_f32_16x16x32_bf16 v[124:127], a[196:199], a[32:35], v[124:127]
    v_exp_f32 v159, v159
    v_mfma_f32_16x16x32_bf16 v[128:131], a[180:183], a[4:7], 0
    v_add_f32 v158, 1.0, v158
    buffer_load_dwordx4 v54, s[20:23], s65 offen offset:2048 sc1 lds
    v_mfma_f32_16x16x32_bf16 v[128:131], a[184:187], a[12:15], v[128:131]
    v_add_f32 v159, 1.0, v159
    v_rcp_f32 v158, v158
    v_mfma_f32_16x16x32_bf16 v[128:131], a[188:191], a[20:23], v[128:131]
    v_rcp_f32 v159, v159
    v_mfma_f32_16x16x32_bf16 v[128:131], a[192:195], a[28:31], v[128:131]
    v_mul_f32 v158, v158, v174
    v_mul_f32 v159, v159, v175
    v_mfma_f32_16x16x32_bf16 v[128:131], a[196:199], a[36:39], v[128:131]
    ds_read_b128 a[180:183], v3 offset:3072
    s_waitcnt lgkmcnt(1)
    v_mfma_f32_16x16x32_bf16 v[132:135], a[160:163], a[0:3], 0
    ds_read_b128 a[184:187], v3 offset:7168
    buffer_load_dwordx4 v55, s[20:23], s65 offen offset:3072 sc1 lds
    v_cvt_pk_bf16_f32 v167, v158, v159
    v_mfma_f32_16x16x32_bf16 v[132:135], a[164:167], a[8:11], v[132:135]
    ds_read_b128 a[188:191], v3 offset:11264
    s_add_u32 m0, s45, 86016
    v_mfma_f32_16x16x32_bf16 v[132:135], a[168:171], a[16:19], v[132:135]
    ds_read_b128 a[192:195], v3 offset:15360
    v_mul_f32 v155, 0xbfb8aa3b, v155
    v_mfma_f32_16x16x32_bf16 v[132:135], a[172:175], a[24:27], v[132:135]
    ds_read_b128 a[196:199], v3 offset:19456
    v_mul_f32 v160, 0xbfb8aa3b, v160
    v_mfma_f32_16x16x32_bf16 v[132:135], a[176:179], a[32:35], v[132:135]
    s_add_u32 s53, s3, 57344
    buffer_store_dwordx4 v[164:167], v1, s[8:11], s53 offen sc1
    v_mul_f32 v161, 0xbfb8aa3b, v161
    v_mfma_f32_16x16x32_bf16 v[136:139], a[160:163], a[4:7], 0
    v_exp_f32 v152, v152
    v_mfma_f32_16x16x32_bf16 v[136:139], a[164:167], a[12:15], v[136:139]
    v_exp_f32 v153, v153
    v_mfma_f32_16x16x32_bf16 v[136:139], a[168:171], a[20:23], v[136:139]
    v_exp_f32 v154, v154
    v_mfma_f32_16x16x32_bf16 v[136:139], a[172:175], a[28:31], v[136:139]
    v_exp_f32 v155, v155
    v_add_f32 v152, 1.0, v152
    v_mfma_f32_16x16x32_bf16 v[136:139], a[176:179], a[36:39], v[136:139]
    s_barrier
    ds_read_b128 a[160:163], v1 offset:0
    s_waitcnt lgkmcnt(1)
    v_mfma_f32_16x16x32_bf16 v[140:143], a[180:183], a[0:3], 0
    ds_read_b128 a[164:167], v1 offset:4096
    buffer_load_dwordx4 v56, s[20:23], s65 offen sc1 lds
    v_mfma_f32_16x16x32_bf16 v[140:143], a[184:187], a[8:11], v[140:143]
    ds_read_b128 a[168:171], v1 offset:8192
    s_add_u32 m0, s45, 102400
    v_mfma_f32_16x16x32_bf16 v[140:143], a[188:191], a[16:19], v[140:143]
    ds_read_b128 a[172:175], v1 offset:12288
    v_exp_f32 v160, v160
    v_mfma_f32_16x16x32_bf16 v[140:143], a[192:195], a[24:27], v[140:143]
    ds_read_b128 a[176:179], v1 offset:16384
    v_add_f32 v153, 1.0, v153
    v_mfma_f32_16x16x32_bf16 v[140:143], a[196:199], a[32:35], v[140:143]
    v_rcp_f32 v152, v152
    v_mfma_f32_16x16x32_bf16 v[144:147], a[180:183], a[4:7], 0
    buffer_load_dwordx4 v52, s[16:19], s66 offen sc1 lds
    v_add_f32 v154, 1.0, v154
    v_mfma_f32_16x16x32_bf16 v[144:147], a[184:187], a[12:15], v[144:147]
    v_rcp_f32 v153, v153
    v_mul_f32 v152, v152, v168
    v_mfma_f32_16x16x32_bf16 v[144:147], a[188:191], a[20:23], v[144:147]
    v_exp_f32 v161, v161
    v_mfma_f32_16x16x32_bf16 v[144:147], a[192:195], a[28:31], v[144:147]
    v_mul_f32 v153, v153, v169
    v_cvt_pk_bf16_f32 v168, v152, v153
    v_mfma_f32_16x16x32_bf16 v[144:147], a[196:199], a[36:39], v[144:147]
    ds_read_b128 a[180:183], v1 offset:1024
    s_waitcnt lgkmcnt(1)
    v_mfma_f32_16x16x32_bf16 v[116:119], a[160:163], a[40:43], v[116:119]
    ds_read_b128 a[184:187], v1 offset:5120
    buffer_load_dwordx4 v53, s[16:19], s66 offen offset:1024 sc1 lds
    v_add_f32 v155, 1.0, v155
    v_mfma_f32_16x16x32_bf16 v[116:119], a[164:167], a[48:51], v[116:119]
    ds_read_b128 a[188:191], v1 offset:9216
    v_add_f32 v160, 1.0, v160
    v_mfma_f32_16x16x32_bf16 v[116:119], a[168:171], a[56:59], v[116:119]
    ds_read_b128 a[192:195], v1 offset:13312
    v_add_f32 v161, 1.0, v161
    v_mfma_f32_16x16x32_bf16 v[116:119], a[172:175], a[64:67], v[116:119]
    ds_read_b128 a[196:199], v1 offset:17408
    v_mul_f32 v162, 0xbfb8aa3b, v162
    v_mfma_f32_16x16x32_bf16 v[116:119], a[176:179], a[72:75], v[116:119]
    v_rcp_f32 v154, v154
    v_mul_f32 v163, 0xbfb8aa3b, v163
    v_mfma_f32_16x16x32_bf16 v[120:123], a[160:163], a[44:47], v[120:123]
    buffer_load_dwordx4 v54, s[16:19], s66 offen offset:2048 sc1 lds
    v_mfma_f32_16x16x32_bf16 v[120:123], a[164:167], a[52:55], v[120:123]
    v_rcp_f32 v155, v155
    v_mfma_f32_16x16x32_bf16 v[120:123], a[168:171], a[60:63], v[120:123]
    v_rcp_f32 v160, v160
    v_mfma_f32_16x16x32_bf16 v[120:123], a[172:175], a[68:71], v[120:123]
    v_rcp_f32 v161, v161
    v_mul_f32 v154, v154, v170
    v_mfma_f32_16x16x32_bf16 v[120:123], a[176:179], a[76:79], v[120:123]
    ds_read_b128 a[160:163], v1 offset:2048
    s_waitcnt lgkmcnt(1)
    v_mfma_f32_16x16x32_bf16 v[124:127], a[180:183], a[40:43], v[124:127]
    ds_read_b128 a[164:167], v1 offset:6144
    buffer_load_dwordx4 v55, s[16:19], s66 offen offset:3072 sc1 lds
    v_mfma_f32_16x16x32_bf16 v[124:127], a[184:187], a[48:51], v[124:127]
    ds_read_b128 a[168:171], v1 offset:10240
    s_add_u32 m0, s45, 106496
    v_mfma_f32_16x16x32_bf16 v[124:127], a[188:191], a[56:59], v[124:127]
    ds_read_b128 a[172:175], v1 offset:14336
    v_exp_f32 v162, v162
    v_mfma_f32_16x16x32_bf16 v[124:127], a[192:195], a[64:67], v[124:127]
    ds_read_b128 a[176:179], v1 offset:18432
    v_mul_f32 v155, v155, v171
    v_mfma_f32_16x16x32_bf16 v[124:127], a[196:199], a[72:75], v[124:127]
    v_exp_f32 v163, v163
    v_mfma_f32_16x16x32_bf16 v[128:131], a[180:183], a[44:47], v[128:131]
    buffer_load_dwordx4 v56, s[16:19], s66 offen sc1 lds
    v_cvt_pk_bf16_f32 v169, v154, v155
    v_mfma_f32_16x16x32_bf16 v[128:131], a[184:187], a[52:55], v[128:131]
    v_mul_f32 v160, v160, v176
    v_mul_f32 v161, v161, v177
    v_cvt_pk_bf16_f32 v170, v160, v161
    v_mfma_f32_16x16x32_bf16 v[128:131], a[188:191], a[60:63], v[128:131]
    v_add_f32 v162, 1.0, v162
    v_add_f32 v163, 1.0, v163
    v_mfma_f32_16x16x32_bf16 v[128:131], a[192:195], a[68:71], v[128:131]
    v_rcp_f32 v162, v162
    v_mfma_f32_16x16x32_bf16 v[128:131], a[196:199], a[76:79], v[128:131]
    ds_read_b128 a[180:183], v1 offset:3072
    s_waitcnt lgkmcnt(1)
    v_mfma_f32_16x16x32_bf16 v[132:135], a[160:163], a[40:43], v[132:135]
    ds_read_b128 a[184:187], v1 offset:7168
    v_rcp_f32 v163, v163
    v_mfma_f32_16x16x32_bf16 v[132:135], a[164:167], a[48:51], v[132:135]
    ds_read_b128 a[188:191], v1 offset:11264
    v_mul_f32 v162, v162, v178
    v_mfma_f32_16x16x32_bf16 v[132:135], a[168:171], a[56:59], v[132:135]
    ds_read_b128 a[192:195], v1 offset:15360
    v_mul_f32 v163, v163, v179
    v_mfma_f32_16x16x32_bf16 v[132:135], a[172:175], a[64:67], v[132:135]
    ds_read_b128 a[196:199], v1 offset:19456
    v_cvt_pk_bf16_f32 v171, v162, v163
    v_mfma_f32_16x16x32_bf16 v[132:135], a[176:179], a[72:75], v[132:135]
    s_add_u32 s53, s3, 147456
    buffer_store_dwordx4 v[168:171], v1, s[8:11], s53 offen sc1
    v_mfma_f32_16x16x32_bf16 v[136:139], a[160:163], a[44:47], v[136:139]
    v_mfma_f32_16x16x32_bf16 v[136:139], a[164:167], a[52:55], v[136:139]
    v_mfma_f32_16x16x32_bf16 v[136:139], a[168:171], a[60:63], v[136:139]
    v_mfma_f32_16x16x32_bf16 v[136:139], a[172:175], a[68:71], v[136:139]
    v_mfma_f32_16x16x32_bf16 v[136:139], a[176:179], a[76:79], v[136:139]
    s_barrier
    ds_read_b128 a[160:163], v1 offset:20480
    s_waitcnt lgkmcnt(1)
    v_mfma_f32_16x16x32_bf16 v[140:143], a[180:183], a[40:43], v[140:143]
    ds_read_b128 a[164:167], v1 offset:24576
    s_add_u32 m0, s45, 122880
    v_mfma_f32_16x16x32_bf16 v[140:143], a[184:187], a[48:51], v[140:143]
    ds_read_b128 a[168:171], v1 offset:28672
    buffer_load_dwordx4 v52, s[16:19], s67 offen sc1 lds
    v_mfma_f32_16x16x32_bf16 v[140:143], a[188:191], a[56:59], v[140:143]
    ds_read_b128 a[172:175], v1 offset:32768
    v_mfma_f32_16x16x32_bf16 v[140:143], a[192:195], a[64:67], v[140:143]
    ds_read_b128 a[176:179], v1 offset:36864
    v_mfma_f32_16x16x32_bf16 v[140:143], a[196:199], a[72:75], v[140:143]
    v_mfma_f32_16x16x32_bf16 v[144:147], a[180:183], a[44:47], v[144:147]
    v_mfma_f32_16x16x32_bf16 v[144:147], a[184:187], a[52:55], v[144:147]
    buffer_load_dwordx4 v53, s[16:19], s67 offen offset:1024 sc1 lds
    v_mfma_f32_16x16x32_bf16 v[144:147], a[188:191], a[60:63], v[144:147]
    v_mfma_f32_16x16x32_bf16 v[144:147], a[192:195], a[68:71], v[144:147]
    v_mfma_f32_16x16x32_bf16 v[144:147], a[196:199], a[76:79], v[144:147]
    ds_read_b128 a[180:183], v1 offset:21504
    s_waitcnt lgkmcnt(1)
    v_mfma_f32_16x16x32_bf16 v[116:119], a[160:163], a[80:83], v[116:119]
    ds_read_b128 a[184:187], v1 offset:25600
    buffer_load_dwordx4 v54, s[16:19], s67 offen offset:2048 sc1 lds
    v_mfma_f32_16x16x32_bf16 v[116:119], a[164:167], a[88:91], v[116:119]
    ds_read_b128 a[188:191], v1 offset:29696
    v_mfma_f32_16x16x32_bf16 v[116:119], a[168:171], a[96:99], v[116:119]
    ds_read_b128 a[192:195], v1 offset:33792
    v_mfma_f32_16x16x32_bf16 v[116:119], a[172:175], a[104:107], v[116:119]
    ds_read_b128 a[196:199], v1 offset:37888
    v_mfma_f32_16x16x32_bf16 v[116:119], a[176:179], a[112:115], v[116:119]
    v_mfma_f32_16x16x32_bf16 v[120:123], a[160:163], a[84:87], v[120:123]
    buffer_load_dwordx4 v55, s[16:19], s67 offen offset:3072 sc1 lds
    s_add_u32 m0, s45, 126976
    v_mfma_f32_16x16x32_bf16 v[120:123], a[164:167], a[92:95], v[120:123]
    v_mfma_f32_16x16x32_bf16 v[120:123], a[168:171], a[100:103], v[120:123]
    v_mfma_f32_16x16x32_bf16 v[120:123], a[172:175], a[108:111], v[120:123]
    v_mfma_f32_16x16x32_bf16 v[120:123], a[176:179], a[116:119], v[120:123]
    ds_read_b128 a[160:163], v1 offset:22528
    s_waitcnt lgkmcnt(1)
    v_mfma_f32_16x16x32_bf16 v[124:127], a[180:183], a[80:83], v[124:127]
    ds_read_b128 a[164:167], v1 offset:26624
    buffer_load_dwordx4 v56, s[16:19], s67 offen sc1 lds
    v_mfma_f32_16x16x32_bf16 v[124:127], a[184:187], a[88:91], v[124:127]
    ds_read_b128 a[168:171], v1 offset:30720
    s_add_u32 m0, s45, 143360
    v_mfma_f32_16x16x32_bf16 v[124:127], a[188:191], a[96:99], v[124:127]
    ds_read_b128 a[172:175], v1 offset:34816
    s_add_u32 s0, s95, 69632
    v_mfma_f32_16x16x32_bf16 v[124:127], a[192:195], a[104:107], v[124:127]
    ds_read_b128 a[176:179], v1 offset:38912
    v_mfma_f32_16x16x32_bf16 v[124:127], a[196:199], a[112:115], v[124:127]
    buffer_load_dword v212, v68, s[8:11], s0 offen offset:0 sc1
    v_mfma_f32_16x16x32_bf16 v[128:131], a[180:183], a[84:87], v[128:131]
    v_mfma_f32_16x16x32_bf16 v[128:131], a[184:187], a[92:95], v[128:131]
    buffer_load_dwordx4 v52, s[20:23], s68 offen sc1 lds
    v_mfma_f32_16x16x32_bf16 v[128:131], a[188:191], a[100:103], v[128:131]
    v_mfma_f32_16x16x32_bf16 v[128:131], a[192:195], a[108:111], v[128:131]
    v_mfma_f32_16x16x32_bf16 v[128:131], a[196:199], a[116:119], v[128:131]
    ds_read_b128 a[180:183], v1 offset:23552
    s_waitcnt lgkmcnt(1)
    v_mfma_f32_16x16x32_bf16 v[132:135], a[160:163], a[80:83], v[132:135]
    ds_read_b128 a[184:187], v1 offset:27648
    buffer_load_dwordx4 v53, s[20:23], s68 offen offset:1024 sc1 lds
    v_mfma_f32_16x16x32_bf16 v[132:135], a[164:167], a[88:91], v[132:135]
    ds_read_b128 a[188:191], v1 offset:31744
    v_mfma_f32_16x16x32_bf16 v[132:135], a[168:171], a[96:99], v[132:135]
    ds_read_b128 a[192:195], v1 offset:35840
    v_mfma_f32_16x16x32_bf16 v[132:135], a[172:175], a[104:107], v[132:135]
    ds_read_b128 a[196:199], v1 offset:39936
    v_mfma_f32_16x16x32_bf16 v[132:135], a[176:179], a[112:115], v[132:135]
    v_mfma_f32_16x16x32_bf16 v[136:139], a[160:163], a[84:87], v[136:139]
    buffer_load_dwordx4 v54, s[20:23], s68 offen offset:2048 sc1 lds
    v_mfma_f32_16x16x32_bf16 v[136:139], a[164:167], a[92:95], v[136:139]
    v_mfma_f32_16x16x32_bf16 v[136:139], a[168:171], a[100:103], v[136:139]
    v_mfma_f32_16x16x32_bf16 v[136:139], a[172:175], a[108:111], v[136:139]
    v_mfma_f32_16x16x32_bf16 v[136:139], a[176:179], a[116:119], v[136:139]
    s_barrier
    ds_read_b128 a[160:163], v1 offset:40960
    s_waitcnt lgkmcnt(1)
    v_mfma_f32_16x16x32_bf16 v[140:143], a[180:183], a[80:83], v[140:143]
    ds_read_b128 a[164:167], v1 offset:45056
    buffer_load_dwordx4 v55, s[20:23], s68 offen offset:3072 sc1 lds
    v_mfma_f32_16x16x32_bf16 v[140:143], a[184:187], a[88:91], v[140:143]
    ds_read_b128 a[168:171], v1 offset:49152
    s_add_u32 m0, s45, 147456
    v_mfma_f32_16x16x32_bf16 v[140:143], a[188:191], a[96:99], v[140:143]
    ds_read_b128 a[172:175], v1 offset:53248
    v_mfma_f32_16x16x32_bf16 v[140:143], a[192:195], a[104:107], v[140:143]
    ds_read_b128 a[176:179], v1 offset:57344
    v_mfma_f32_16x16x32_bf16 v[140:143], a[196:199], a[112:115], v[140:143]
    v_mfma_f32_16x16x32_bf16 v[144:147], a[180:183], a[84:87], v[144:147]
    buffer_load_dwordx4 v56, s[20:23], s68 offen sc1 lds
    s_add_u32 m0, s45, 0
    v_mfma_f32_16x16x32_bf16 v[144:147], a[184:187], a[92:95], v[144:147]
    s_waitcnt vmcnt(11)
    s_barrier
    v_mfma_f32_16x16x32_bf16 v[144:147], a[188:191], a[100:103], v[144:147]
    v_mfma_f32_16x16x32_bf16 v[144:147], a[192:195], a[108:111], v[144:147]
    s_add_u32 s53, s56, 139264
    buffer_store_dword v21, v18, s[8:11], s53 offen sc1
    v_mfma_f32_16x16x32_bf16 v[144:147], a[196:199], a[116:119], v[144:147]
    ds_read_b128 a[180:183], v1 offset:41984
    s_waitcnt lgkmcnt(1)
    v_mfma_f32_16x16x32_bf16 v[116:119], a[160:163], a[120:123], v[116:119]
    ds_read_b128 a[184:187], v1 offset:46080
    buffer_load_dwordx4 v52, s[20:23], s69 offen sc1 lds
    v_mfma_f32_16x16x32_bf16 v[116:119], a[164:167], a[128:131], v[116:119]
    ds_read_b128 a[188:191], v1 offset:50176
    v_mfma_f32_16x16x32_bf16 v[116:119], a[168:171], a[136:139], v[116:119]
    ds_read_b128 a[192:195], v1 offset:54272
    v_mfma_f32_16x16x32_bf16 v[116:119], a[172:175], a[144:147], v[116:119]
    ds_read_b128 a[196:199], v1 offset:58368
    v_mfma_f32_16x16x32_bf16 v[116:119], a[176:179], a[152:155], v[116:119]
    v_mfma_f32_16x16x32_bf16 v[120:123], a[160:163], a[124:127], v[120:123]
    buffer_load_dwordx4 v53, s[20:23], s69 offen offset:1024 sc1 lds
    v_mfma_f32_16x16x32_bf16 v[120:123], a[164:167], a[132:135], v[120:123]
    v_mfma_f32_16x16x32_bf16 v[120:123], a[168:171], a[140:143], v[120:123]
    v_mfma_f32_16x16x32_bf16 v[120:123], a[172:175], a[148:151], v[120:123]
    v_mfma_f32_16x16x32_bf16 v[120:123], a[176:179], a[156:159], v[120:123]
    ds_read_b128 a[160:163], v1 offset:43008
    s_waitcnt lgkmcnt(1)
    v_mfma_f32_16x16x32_bf16 v[124:127], a[180:183], a[120:123], v[124:127]
    ds_read_b128 a[164:167], v1 offset:47104
    buffer_load_dwordx4 v54, s[20:23], s69 offen offset:2048 sc1 lds
    v_mfma_f32_16x16x32_bf16 v[124:127], a[184:187], a[128:131], v[124:127]
    ds_read_b128 a[168:171], v1 offset:51200
    s_waitcnt vmcnt(9)
    v_cmp_ne_u32 vcc, s42, v212
    s_cbranch_vccnz L_slow4
L_ok4:
    v_mfma_f32_16x16x32_bf16 v[124:127], a[188:191], a[136:139], v[124:127]
    ds_read_b128 a[172:175], v1 offset:55296
    v_mul_f32 v116, 0xbfb8aa3b, v116
    v_mul_f32 v117, 0xbfb8aa3b, v117
    v_mfma_f32_16x16x32_bf16 v[124:127], a[192:195], a[144:147], v[124:127]
    ds_read_b128 a[176:179], v1 offset:59392
    v_mul_f32 v118, 0xbfb8aa3b, v118
    v_mfma_f32_16x16x32_bf16 v[124:127], a[196:199], a[152:155], v[124:127]
    buffer_load_dwordx4 a[200:203], v57, s[8:11], s74 offen offset:0 sc1
    v_mul_f32 v119, 0xbfb8aa3b, v119
    v_mfma_f32_16x16x32_bf16 v[128:131], a[180:183], a[124:127], v[128:131]
    v_exp_f32 v116, v116
    v_mfma_f32_16x16x32_bf16 v[128:131], a[184:187], a[132:135], v[128:131]
    v_exp_f32 v117, v117
    v_add_f32 v116, 1.0, v116
    v_mfma_f32_16x16x32_bf16 v[128:131], a[188:191], a[140:143], v[128:131]
    v_exp_f32 v118, v118
    v_mfma_f32_16x16x32_bf16 v[128:131], a[192:195], a[148:151], v[128:131]
    buffer_load_dwordx4 a[204:207], v57, s[8:11], s74 offen offset:1024 sc1
    v_add_f32 v117, 1.0, v117
    v_mfma_f32_16x16x32_bf16 v[128:131], a[196:199], a[156:159], v[128:131]
    ds_read_b128 a[180:183], v1 offset:44032
    s_waitcnt lgkmcnt(1)
    v_mfma_f32_16x16x32_bf16 v[132:135], a[160:163], a[120:123], v[132:135]
    ds_read_b128 a[184:187], v1 offset:48128
    v_rcp_f32 v116, v116
    v_mfma_f32_16x16x32_bf16 v[132:135], a[164:167], a[128:131], v[132:135]
    ds_read_b128 a[188:191], v1 offset:52224
    v_mul_f32 v124, 0xbfb8aa3b, v124
    v_mfma_f32_16x16x32_bf16 v[132:135], a[168:171], a[136:139], v[132:135]
    ds_read_b128 a[192:195], v1 offset:56320
    buffer_load_dwordx4 a[208:211], v58, s[8:11], s74 offen offset:0 sc1
    v_mfma_f32_16x16x32_bf16 v[132:135], a[172:175], a[144:147], v[132:135]
    ds_read_b128 a[196:199], v1 offset:60416
    v_mul_f32 v125, 0xbfb8aa3b, v125
    v_mfma_f32_16x16x32_bf16 v[132:135], a[176:179], a[152:155], v[132:135]
    v_rcp_f32 v117, v117
    v_mul_f32 v126, 0xbfb8aa3b, v126
    v_mfma_f32_16x16x32_bf16 v[136:139], a[160:163], a[124:127], v[136:139]
    v_exp_f32 v119, v119
    v_mfma_f32_16x16x32_bf16 v[136:139], a[164:167], a[132:135], v[136:139]
    v_exp_f32 v124, v124
    v_mfma_f32_16x16x32_bf16 v[136:139], a[168:171], a[140:143], v[136:139]
    buffer_load_dwordx4 a[212:215], v58, s[8:11], s74 offen offset:1024 sc1
    v_add_f32 v118, 1.0, v118
    v_mfma_f32_16x16x32_bf16 v[136:139], a[172:175], a[148:151], v[136:139]
    v_exp_f32 v125, v125
    v_add_f32 v119, 1.0, v119
    v_mfma_f32_16x16x32_bf16 v[136:139], a[176:179], a[156:159], v[136:139]
    s_barrier
    v_add_u32 v16, 61440, v59
    v_add_u32 v17, 61440, v60
    ds_read_b128 a[160:163], v16 offset:0
    s_waitcnt lgkmcnt(1)
    v_mfma_f32_16x16x32_bf16 v[140:143], a[180:183], a[120:123], v[140:143]
    ds_read_b128 a[164:167], v17 offset:0
    buffer_load_dwordx4 a[216:219], v57, s[8:11], s74 offen offset:2048 sc1
    v_mfma_f32_16x16x32_bf16 v[140:143], a[184:187], a[128:131], v[140:143]
    v_rcp_f32 v118, v118
    v_mfma_f32_16x16x32_bf16 v[140:143], a[188:191], a[136:139], v[140:143]
    v_rcp_f32 v119, v119
    v_add_f32 v124, 1.0, v124
    v_mfma_f32_16x16x32_bf16 v[140:143], a[192:195], a[144:147], v[140:143]
    ds_read_b128 a[168:171], v16 offset:1024
    v_add_f32 v125, 1.0, v125
    v_mfma_f32_16x16x32_bf16 v[140:143], a[196:199], a[152:155], v[140:143]
    ds_read_b128 a[172:175], v17 offset:1024
    buffer_load_dwordx4 a[220:223], v57, s[8:11], s74 offen offset:3072 sc1
    v_mfma_f32_16x16x32_bf16 v[144:147], a[180:183], a[124:127], v[144:147]
    v_rcp_f32 v124, v124
    v_mfma_f32_16x16x32_bf16 v[144:147], a[184:187], a[132:135], v[144:147]
    v_rcp_f32 v125, v125
    v_mul_f32 v127, 0xbfb8aa3b, v127
    v_mfma_f32_16x16x32_bf16 v[144:147], a[188:191], a[140:143], v[144:147]
    ds_read_b128 a[176:179], v16 offset:2048
    v_mul_f32 v120, 0xbfb8aa3b, v120
    v_mfma_f32_16x16x32_bf16 v[144:147], a[192:195], a[148:151], v[144:147]
    ds_read_b128 a[180:183], v17 offset:2048
    buffer_load_dwordx4 a[224:227], v58, s[8:11], s74 offen offset:2048 sc1
    v_mfma_f32_16x16x32_bf16 v[144:147], a[196:199], a[156:159], v[144:147]
    v_mul_f32 v116, v116, v132
    v_exp_f32 v126, v126
    v_exp_f32 v127, v127
    v_mul_f32 v117, v117, v133
    v_cvt_pk_bf16_f32 v132, v116, v117
    v_mul_f32 v118, v118, v134
    buffer_load_dwordx4 a[228:231], v58, s[8:11], s74 offen offset:3072 sc1
    v_mul_f32 v119, v119, v135
    v_cvt_pk_bf16_f32 v133, v118, v119
    v_mul_f32 v124, v124, v140
    v_mul_f32 v125, v125, v141
    v_cvt_pk_bf16_f32 v134, v124, v125
    v_add_f32 v126, 1.0, v126
    v_add_f32 v127, 1.0, v127
    v_rcp_f32 v126, v126
    v_rcp_f32 v127, v127
    buffer_load_dwordx4 a[232:235], v57, s[8:11], s75 offen offset:0 sc1
    v_mul_f32 v126, v126, v142
    v_mul_f32 v127, v127, v143
    v_cvt_pk_bf16_f32 v135, v126, v127
    s_add_u32 s53, s3, 73728
    buffer_store_dwordx4 v[132:135], v1, s[8:11], s53 offen sc1
    v_mul_f32 v121, 0xbfb8aa3b, v121
    v_exp_f32 v120, v120
    v_exp_f32 v121, v121
    v_add_f32 v120, 1.0, v120
    v_add_f32 v121, 1.0, v121
    v_rcp_f32 v120, v120
    v_rcp_f32 v121, v121
    v_mul_f32 v120, v120, v136
    v_mul_f32 v121, v121, v137
    buffer_load_dwordx4 a[236:239], v57, s[8:11], s75 offen offset:1024 sc1
    v_cvt_pk_bf16_f32 v136, v120, v121
    v_mul_f32 v122, 0xbfb8aa3b, v122
    v_mul_f32 v123, 0xbfb8aa3b, v123
    v_exp_f32 v122, v122
    v_exp_f32 v123, v123
    v_add_f32 v122, 1.0, v122
    v_add_f32 v123, 1.0, v123
    v_rcp_f32 v122, v122
    v_rcp_f32 v123, v123
    v_mul_f32 v122, v122, v138
    buffer_load_dwordx4 a[240:243], v58, s[8:11], s75 offen offset:0 sc1
    v_mul_f32 v123, v123, v139
    v_cvt_pk_bf16_f32 v137, v122, v123
    v_mul_f32 v128, 0xbfb8aa3b, v128
    v_mul_f32 v129, 0xbfb8aa3b, v129
    v_exp_f32 v128, v128
    v_exp_f32 v129, v129
    v_add_f32 v128, 1.0, v128
    v_add_f32 v129, 1.0, v129
    v_rcp_f32 v128, v128
    v_rcp_f32 v129, v129
    buffer_load_dwordx4 a[244:247], v58, s[8:11], s75 offen offset:1024 sc1
    buffer_load_dwordx4 a[248:251], v57, s[8:11], s75 offen offset:2048 sc1
    buffer_load_dwordx4 a[252:255], v57, s[8:11], s75 offen offset:3072 sc1
    s_waitcnt vmcnt(11) lgkmcnt(2)
    v_mfma_f32_16x16x32_bf16 v[76:79], a[160:163], a[200:203], 0
    v_mul_f32 v128, v128, v144
    v_mul_f32 v129, v129, v145
    v_mfma_f32_16x16x32_bf16 v[76:79], a[164:167], a[204:207], v[76:79]
    ds_read_b128 a[184:187], v16 offset:3072
    v_cvt_pk_bf16_f32 v138, v128, v129
    v_mfma_f32_16x16x32_bf16 v[96:99], a[160:163], a[208:211], 0
    ds_read_b128 a[188:191], v17 offset:3072
    v_mul_f32 v130, 0xbfb8aa3b, v130
    v_mfma_f32_16x16x32_bf16 v[96:99], a[164:167], a[212:215], v[96:99]
    buffer_load_dwordx4 a[0:3], v58, s[8:11], s75 offen offset:2048 sc1
    v_mul_f32 v131, 0xbfb8aa3b, v131
    v_mfma_f32_16x16x32_bf16 v[80:83], a[168:171], a[200:203], 0
    v_exp_f32 v130, v130
    v_mfma_f32_16x16x32_bf16 v[80:83], a[172:175], a[204:207], v[80:83]
    ds_read_b128 a[192:195], v16 offset:4096
    v_mfma_f32_16x16x32_bf16 v[100:103], a[168:171], a[208:211], 0
    ds_read_b128 a[196:199], v17 offset:4096
    v_mfma_f32_16x16x32_bf16 v[100:103], a[172:175], a[212:215], v[100:103]
    s_waitcnt lgkmcnt(2)
    v_mfma_f32_16x16x32_bf16 v[84:87], a[176:179], a[200:203], 0
    v_exp_f32 v131, v131
    v_mfma_f32_16x16x32_bf16 v[84:87], a[180:183], a[204:207], v[84:87]
    ds_read_b128 a[160:163], v16 offset:10240
    v_add_f32 v130, 1.0, v130
    v_mfma_f32_16x16x32_bf16 v[104:107], a[176:179], a[208:211], 0
    ds_read_b128 a[164:167], v17 offset:10240
    v_add_f32 v131, 1.0, v131
    v_mfma_f32_16x16x32_bf16 v[104:107], a[180:183], a[212:215], v[104:107]
    buffer_load_dwordx4 a[4:7], v58, s[8:11], s75 offen offset:3072 sc1
    v_mfma_f32_16x16x32_bf16 v[88:91], a[184:187], a[200:203], 0
    v_rcp_f32 v130, v130
    v_mfma_f32_16x16x32_bf16 v[88:91], a[188:191], a[204:207], v[88:91]
    ds_read_b128 a[168:171], v16 offset:11264
    v_mfma_f32_16x16x32_bf16 v[108:111], a[184:187], a[208:211], 0
    ds_read_b128 a[172:175], v17 offset:11264
    v_mfma_f32_16x16x32_bf16 v[108:111], a[188:191], a[212:215], v[108:111]
    s_waitcnt lgkmcnt(2)
    v_mfma_f32_16x16x32_bf16 v[92:95], a[192:195], a[200:203], 0
    buffer_load_dwordx4 a[8:11], v57, s[8:11], s76 offen offset:0 sc1
    v_mfma_f32_16x16x32_bf16 v[92:95], a[196:199], a[204:207], v[92:95]
    ds_read_b128 a[176:179], v16 offset:12288
    v_mfma_f32_16x16x32_bf16 v[112:115], a[192:195], a[208:211], 0
    ds_read_b128 a[180:183], v17 offset:12288
    v_mfma_f32_16x16x32_bf16 v[112:115], a[196:199], a[212:215], v[112:115]
    buffer_load_dwordx4 a[12:15], v57, s[8:11], s76 offen offset:1024 sc1
    s_waitcnt vmcnt(11)
    v_mfma_f32_16x16x32_bf16 v[76:79], a[160:163], a[216:219], v[76:79]
    v_rcp_f32 v131, v131
    v_mfma_f32_16x16x32_bf16 v[76:79], a[164:167], a[220:223], v[76:79]
    ds_read_b128 a[184:187], v16 offset:13312
    v_mul_f32 v130, v130, v146
    v_mfma_f32_16x16x32_bf16 v[96:99], a[160:163], a[224:227], v[96:99]
L_pad4:
    s_cbranch_execz L_back
    ds_read_b128 a[188:191], v17 offset:13312
    v_mul_f32 v131, v131, v147
    v_mfma_f32_16x16x32_bf16 v[96:99], a[164:167], a[228:231], v[96:99]
    v_cvt_pk_bf16_f32 v139, v130, v131
    s_waitcnt lgkmcnt(2)
    v_mfma_f32_16x16x32_bf16 v[80:83], a[168:171], a[216:219], v[80:83]
    buffer_load_dwordx4 a[16:19], v58, s[8:11], s76 offen offset:0 sc1
    v_mfma_f32_16x16x32_bf16 v[80:83], a[172:175], a[220:223], v[80:83]
    ds_read_b128 a[192:195], v16 offset:14336
    v_mfma_f32_16x16x32_bf16 v[100:103], a[168:171], a[224:227], v[100:103]
    ds_read_b128 a[196:199], v17 offset:14336
    s_add_u32 s53, s3, 163840
    buffer_store_dwordx4 v[136:139], v1, s[8:11], s53 offen sc1
    v_mfma_f32_16x16x32_bf16 v[100:103], a[172:175], a[228:231], v[100:103]
    v_mfma_f32_16x16x32_bf16 v[84:87], a[176:179], a[216:219], v[84:87]
    v_mfma_f32_16x16x32_bf16 v[84:87], a[180:183], a[220:223], v[84:87]
    s_barrier
    ds_read_b128 a[160:163], v16 offset:20480
    v_mfma_f32_16x16x32_bf16 v[104:107], a[176:179], a[224:227], v[104:107]
    ds_read_b128 a[164:167], v17 offset:20480
    buffer_load_dwordx4 a[20:23], v58, s[8:11], s76 offen offset:1024 sc1
    v_mfma_f32_16x16x32_bf16 v[104:107], a[180:183], a[228:231], v[104:107]
    s_waitcnt lgkmcnt(2)
    v_mfma_f32_16x16x32_bf16 v[88:91], a[184:187], a[216:219], v[88:91]
    v_mfma_f32_16x16x32_bf16 v[88:91], a[188:191], a[220:223], v[88:91]
    ds_read_b128 a[168:171], v16 offset:21504
    buffer_load_dwordx4 a[24:27], v57, s[8:11], s76 offen offset:2048 sc1
    v_mfma_f32_16x16x32_bf16 v[108:111], a[184:187], a[224:227], v[108:111]
    ds_read_b128 a[172:175], v17 offset:21504
    v_mfma_f32_16x16x32_bf16 v[108:111], a[188:191], a[228:231], v[108:111]
    v_mfma_f32_16x16x32_bf16 v[92:95], a[192:195], a[216:219], v[92:95]
    buffer_load_dwordx4 a[28:31], v57, s[8:11], s76 offen offset:3072 sc1
    v_mfma_f32_16x16x32_bf16 v[92:95], a[196:199], a[220:223], v[92:95]
    ds_read_b128 a[176:179], v16 offset:22528
    v_mfma_f32_16x16x32_bf16 v[112:115], a[192:195], a[224:227], v[112:115]
    ds_read_b128 a[180:183], v17 offset:22528
    v_mfma_f32_16x16x32_bf16 v[112:115], a[196:199], a[228:231], v[112:115]
    s_add_u32 s0, s95, 139264
    s_waitcnt vmcnt(11) lgkmcnt(2)
    v_mfma_f32_16x16x32_bf16 v[76:79], a[160:163], a[232:235], v[76:79]
    buffer_load_dword v212, v68, s[8:11], s0 offen offset:0 sc1
    buffer_load_dwordx4 a[32:35], v58, s[8:11], s76 offen offset:2048 sc1
    v_mfma_f32_16x16x32_bf16 v[76:79], a[164:167], a[236:239], v[76:79]
    ds_read_b128 a[184:187], v16 offset:23552
    v_lshrrev_b32 v71, 4, v0
    v_mfma_f32_16x16x32_bf16 v[96:99], a[160:163], a[240:243], v[96:99]
    ds_read_b128 a[188:191], v17 offset:23552
    v_lshlrev_b32 v74, 3, v71
    v_mfma_f32_16x16x32_bf16 v[96:99], a[164:167], a[244:247], v[96:99]
    s_mul_i32 s53, s40, 160
    v_add_u32 v74, s53, v74
    v_mfma_f32_16x16x32_bf16 v[80:83], a[168:171], a[232:235], v[80:83]
    global_load_dwordx2 v[116:117], v74, s[62:63] offset:0
    v_mfma_f32_16x16x32_bf16 v[80:83], a[172:175], a[236:239], v[80:83]
    ds_read_b128 a[192:195], v16 offset:24576
    v_mfma_f32_16x16x32_bf16 v[100:103], a[168:171], a[240:243], v[100:103]
    ds_read_b128 a[196:199], v17 offset:24576
    global_load_dwordx2 v[118:119], v74, s[62:63] offset:32
    v_mfma_f32_16x16x32_bf16 v[100:103], a[172:175], a[244:247], v[100:103]
    s_waitcnt lgkmcnt(2)
    v_mfma_f32_16x16x32_bf16 v[84:87], a[176:179], a[232:235], v[84:87]
    global_load_dwordx2 v[120:121], v74, s[62:63] offset:64
    v_mfma_f32_16x16x32_bf16 v[84:87], a[180:183], a[236:239], v[84:87]
    ds_read_b128 a[160:163], v16 offset:30720
    v_mfma_f32_16x16x32_bf16 v[104:107], a[176:179], a[240:243], v[104:107]
    ds_read_b128 a[164:167], v17 offset:30720
    global_load_dwordx2 v[122:123], v74, s[62:63] offset:96
    v_mfma_f32_16x16x32_bf16 v[104:107], a[180:183], a[244:247], v[104:107]
    v_mfma_f32_16x16x32_bf16 v[88:91], a[184:187], a[232:235], v[88:91]
    global_load_dwordx2 v[124:125], v74, s[62:63] offset:128
    buffer_load_dwordx4 a[36:39], v58, s[8:11], s76 offen offset:3072 sc1
    v_mfma_f32_16x16x32_bf16 v[88:91], a[188:191], a[236:239], v[88:91]
    ds_read_b128 a[168:171], v16 offset:31744
    s_mul_i32 s101, s36, 5376
    s_add_u32 s101, s101, 61440
    v_mfma_f32_16x16x32_bf16 v[108:111], a[184:187], a[240:243], v[108:111]
    ds_read_b128 a[172:175], v17 offset:31744
    buffer_load_dwordx4 a[40:43], v57, s[8:11], s77 offen offset:0 sc1
    v_mfma_f32_16x16x32_bf16 v[108:111], a[188:191], a[244:247], v[108:111]
    v_add_lshl_u32 v72, v68, v71, 2
    s_waitcnt lgkmcnt(2)
    v_mfma_f32_16x16x32_bf16 v[92:95], a[192:195], a[232:235], v[92:95]
    ds_bpermute_b32 v236, v72, v236
    ds_bpermute_b32 v237, v72, v237
    buffer_load_dwordx4 a[44:47], v57, s[8:11], s77 offen offset:1024 sc1
    v_mfma_f32_16x16x32_bf16 v[92:95], a[196:199], a[236:239], v[92:95]
    ds_read_b128 a[176:179], v16 offset:32768
    ds_bpermute_b32 v238, v72, v238
    v_mfma_f32_16x16x32_bf16 v[112:115], a[192:195], a[240:243], v[112:115]
    ds_read_b128 a[180:183], v17 offset:32768
    ds_bpermute_b32 v239, v72, v239
    buffer_load_dwordx4 a[48:51], v58, s[8:11], s77 offen offset:0 sc1
    v_mfma_f32_16x16x32_bf16 v[112:115], a[196:199], a[244:247], v[112:115]
    ds_bpermute_b32 v240, v72, v240
    s_waitcnt vmcnt(18)
    v_mfma_f32_16x16x32_bf16 v[76:79], a[160:163], a[248:251], v[76:79]
    ds_bpermute_b32 v241, v72, v241
    ds_bpermute_b32 v242, v72, v242
    v_mfma_f32_16x16x32_bf16 v[76:79], a[164:167], a[252:255], v[76:79]
    ds_read_b128 a[184:187], v16 offset:33792
    ds_bpermute_b32 v243, v72, v243
    v_mfma_f32_16x16x32_bf16 v[96:99], a[160:163], a[0:3], v[96:99]
    ds_read_b128 a[188:191], v17 offset:33792
    ds_bpermute_b32 v244, v72, v244
    v_mfma_f32_16x16x32_bf16 v[96:99], a[164:167], a[4:7], v[96:99]
    ds_bpermute_b32 v245, v72, v245
    s_waitcnt lgkmcnt(9)
    v_mfma_f32_16x16x32_bf16 v[80:83], a[168:171], a[248:251], v[80:83]
    v_mul_u32_u24 v73, 84, v68
    v_lshl_add_u32 v73, v71, 4, v73
    v_mfma_f32_16x16x32_bf16 v[80:83], a[172:175], a[252:255], v[80:83]
    ds_read_b128 a[192:195], v16 offset:34816
    v_add_u32 v153, s101, v73
    v_mfma_f32_16x16x32_bf16 v[100:103], a[168:171], a[0:3], v[100:103]
    ds_read_b128 a[196:199], v17 offset:34816
    s_lshl_b32 s99, s99, 1
    v_mfma_f32_16x16x32_bf16 v[100:103], a[172:175], a[4:7], v[100:103]
    v_add_u32 v71, 0, v0
    v_mul_u32_u24 v74, 3277, v71
    v_mfma_f32_16x16x32_bf16 v[84:87], a[176:179], a[248:251], v[84:87]
    buffer_load_dwordx4 a[52:55], v58, s[8:11], s77 offen offset:1024 sc1
    v_lshrrev_b32 v74, 16, v74
    v_mfma_f32_16x16x32_bf16 v[84:87], a[180:183], a[252:255], v[84:87]
    s_barrier
    ds_read_b128 a[160:163], v16 offset:40960
    v_mfma_f32_16x16x32_bf16 v[104:107], a[176:179], a[0:3], v[104:107]
    ds_read_b128 a[164:167], v17 offset:40960
    buffer_load_dwordx4 a[56:59], v57, s[8:11], s77 offen offset:2048 sc1
    v_mfma_f32_16x16x32_bf16 v[104:107], a[180:183], a[4:7], v[104:107]
    v_mul_u32_u24 v73, 20, v74
    s_waitcnt lgkmcnt(2)
    v_mfma_f32_16x16x32_bf16 v[88:91], a[184:187], a[248:251], v[88:91]
    v_sub_u32 v73, v71, v73
    v_add_lshl_u32 v71, v71, v74, 4
    v_mfma_f32_16x16x32_bf16 v[88:91], a[188:191], a[252:255], v[88:91]
    ds_read_b128 a[168:171], v16 offset:41984
    v_add_u32 v154, s101, v71
    v_mfma_f32_16x16x32_bf16 v[108:111], a[184:187], a[0:3], v[108:111]
    ds_read_b128 a[172:175], v17 offset:41984
    buffer_load_dwordx4 a[60:63], v57, s[8:11], s77 offen offset:3072 sc1
    v_mfma_f32_16x16x32_bf16 v[108:111], a[188:191], a[4:7], v[108:111]
    v_and_b32 v71, 12, v74
    v_add_u32 v74, v74, v71
    v_mfma_f32_16x16x32_bf16 v[92:95], a[192:195], a[248:251], v[92:95]
    v_mul_u32_u24 v74, 2560, v74
    v_lshl_add_u32 v148, v73, 4, v74
    v_mfma_f32_16x16x32_bf16 v[92:95], a[196:199], a[252:255], v[92:95]
    ds_read_b128 a[176:179], v16 offset:43008
    v_add_u32 v71, 64, v0
    v_mfma_f32_16x16x32_bf16 v[112:115], a[192:195], a[0:3], v[112:115]
    ds_read_b128 a[180:183], v17 offset:43008
    buffer_load_dwordx4 a[64:67], v58, s[8:11], s77 offen offset:2048 sc1
    v_mfma_f32_16x16x32_bf16 v[112:115], a[196:199], a[4:7], v[112:115]
    s_waitcnt vmcnt(14)
    v_cmp_ne_u32 vcc, s42, v212
    s_cbranch_vccnz L_slow5
L_ok5:
    s_waitcnt lgkmcnt(2)
    v_mfma_f32_16x16x32_bf16 v[76:79], a[160:163], a[8:11], v[76:79]
    s_barrier
    v_mfma_f32_16x16x32_bf16 v[76:79], a[164:167], a[12:15], v[76:79]
    ds_read_b128 a[184:187], v16 offset:44032
    s_add_u32 s53, s56, 208896
    buffer_store_dword v21, v18, s[8:11], s53 offen sc1
    v_mfma_f32_16x16x32_bf16 v[96:99], a[160:163], a[16:19], v[96:99]
    ds_read_b128 a[188:191], v17 offset:44032
    buffer_load_dwordx4 a[68:71], v58, s[8:11], s77 offen offset:3072 sc1
    v_mfma_f32_16x16x32_bf16 v[96:99], a[164:167], a[20:23], v[96:99]
    v_mul_u32_u24 v74, 3277, v71
    v_lshrrev_b32 v74, 16, v74
    v_mfma_f32_16x16x32_bf16 v[80:83], a[168:171], a[8:11], v[80:83]
    v_mul_u32_u24 v73, 20, v74
    v_sub_u32 v73, v71, v73
    v_mfma_f32_16x16x32_bf16 v[80:83], a[172:175], a[12:15], v[80:83]
    ds_read_b128 a[192:195], v16 offset:45056
    v_add_lshl_u32 v71, v71, v74, 4
    v_mfma_f32_16x16x32_bf16 v[100:103], a[168:171], a[16:19], v[100:103]
    ds_read_b128 a[196:199], v17 offset:45056
    v_add_u32 v155, s101, v71
    v_mfma_f32_16x16x32_bf16 v[100:103], a[172:175], a[20:23], v[100:103]
    v_and_b32 v71, 12, v74
    s_waitcnt lgkmcnt(2)
    v_mfma_f32_16x16x32_bf16 v[84:87], a[176:179], a[8:11], v[84:87]
    v_add_u32 v74, v74, v71
    v_mul_u32_u24 v74, 2560, v74
    v_mfma_f32_16x16x32_bf16 v[84:87], a[180:183], a[12:15], v[84:87]
    ds_read_b128 a[160:163], v16 offset:51200
    v_lshl_add_u32 v149, v73, 4, v74
    v_mfma_f32_16x16x32_bf16 v[104:107], a[176:179], a[16:19], v[104:107]
    ds_read_b128 a[164:167], v17 offset:51200
    v_add_u32 v71, 128, v0
    v_mfma_f32_16x16x32_bf16 v[104:107], a[180:183], a[20:23], v[104:107]
    v_mul_u32_u24 v74, 3277, v71
    v_lshrrev_b32 v74, 16, v74
    v_mfma_f32_16x16x32_bf16 v[88:91], a[184:187], a[8:11], v[88:91]
    v_mul_u32_u24 v73, 20, v74
    v_sub_u32 v73, v71, v73
    v_mfma_f32_16x16x32_bf16 v[88:91], a[188:191], a[12:15], v[88:91]
    ds_read_b128 a[168:171], v16 offset:52224
    v_add_lshl_u32 v71, v71, v74, 4
    v_mfma_f32_16x16x32_bf16 v[108:111], a[184:187], a[16:19], v[108:111]
    ds_read_b128 a[172:175], v17 offset:52224
    v_add_u32 v156, s101, v71
    v_mfma_f32_16x16x32_bf16 v[108:111], a[188:191], a[20:23], v[108:111]
    v_and_b32 v71, 12, v74
    s_waitcnt lgkmcnt(2)
    v_mfma_f32_16x16x32_bf16 v[92:95], a[192:195], a[8:11], v[92:95]
    v_add_u32 v74, v74, v71
    buffer_load_dwordx4 a[72:75], v57, s[8:11], s78 offen offset:0 sc1
    v_mfma_f32_16x16x32_bf16 v[92:95], a[196:199], a[12:15], v[92:95]
    ds_read_b128 a[176:179], v16 offset:53248
    v_mul_u32_u24 v74, 2560, v74
    v_mfma_f32_16x16x32_bf16 v[112:115], a[192:195], a[16:19], v[112:115]
    ds_read_b128 a[180:183], v17 offset:53248
    v_lshl_add_u32 v150, v73, 4, v74
    v_mfma_f32_16x16x32_bf16 v[112:115], a[196:199], a[20:23], v[112:115]
    v_add_u32 v71, 192, v0
    v_mul_u32_u24 v74, 3277, v71
    v_mfma_f32_16x16x32_bf16 v[76:79], a[160:163], a[24:27], v[76:79]
    v_lshrrev_b32 v74, 16, v74
    v_mul_u32_u24 v73, 20, v74
    buffer_load_dwordx4 a[76:79], v57, s[8:11], s78 offen offset:1024 sc1
    v_mfma_f32_16x16x32_bf16 v[76:79], a[164:167], a[28:31], v[76:79]
    ds_read_b128 a[184:187], v16 offset:54272
    s_waitcnt vmcnt(17)
    v_mfma_f32_16x16x32_bf16 v[96:99], a[160:163], a[32:35], v[96:99]
    ds_read_b128 a[188:191], v17 offset:54272
    buffer_load_dwordx4 a[80:83], v58, s[8:11], s78 offen offset:0 sc1
    s_waitcnt vmcnt(12)
    v_mfma_f32_16x16x32_bf16 v[96:99], a[164:167], a[36:39], v[96:99]
    v_sub_u32 v73, v71, v73
    s_waitcnt lgkmcnt(2)
    v_mfma_f32_16x16x32_bf16 v[80:83], a[168:171], a[24:27], v[80:83]
    v_add_lshl_u32 v71, v71, v74, 4
    v_add_u32 v157, s101, v71
    v_mfma_f32_16x16x32_bf16 v[80:83], a[172:175], a[28:31], v[80:83]
    ds_read_b128 a[192:195], v16 offset:55296
    v_and_b32 v71, 12, v74
    v_mfma_f32_16x16x32_bf16 v[100:103], a[168:171], a[32:35], v[100:103]
    ds_read_b128 a[196:199], v17 offset:55296
    v_add_u32 v74, v74, v71
    v_mfma_f32_16x16x32_bf16 v[100:103], a[172:175], a[36:39], v[100:103]
    buffer_load_dwordx4 a[84:87], v58, s[8:11], s78 offen offset:1024 sc1
    v_mul_u32_u24 v74, 2560, v74
    v_mfma_f32_16x16x32_bf16 v[84:87], a[176:179], a[24:27], v[84:87]
    v_lshl_add_u32 v151, v73, 4, v74
    v_add_u32 v71, 256, v0
    v_mfma_f32_16x16x32_bf16 v[84:87], a[180:183], a[28:31], v[84:87]
    s_barrier
    v_add_u32 v14, 122880, v59
    v_add_u32 v15, 122880, v60
    ds_read_b128 a[160:163], v14 offset:0
    v_mfma_f32_16x16x32_bf16 v[104:107], a[176:179], a[32:35], v[104:107]
    ds_read_b128 a[164:167], v15 offset:0
    buffer_load_dwordx4 a[88:91], v57, s[8:11], s78 offen offset:2048 sc1
    v_mfma_f32_16x16x32_bf16 v[104:107], a[180:183], a[36:39], v[104:107]
    v_mul_u32_u24 v74, 3277, v71
    s_waitcnt lgkmcnt(2)
    v_mfma_f32_16x16x32_bf16 v[88:91], a[184:187], a[24:27], v[88:91]
    v_lshrrev_b32 v74, 16, v74
    v_mul_u32_u24 v73, 20, v74
    buffer_load_dwordx4 a[92:95], v57, s[8:11], s78 offen offset:3072 sc1
    v_mfma_f32_16x16x32_bf16 v[88:91], a[188:191], a[28:31], v[88:91]
    ds_read_b128 a[168:171], v14 offset:1024
    v_sub_u32 v73, v71, v73
    v_mfma_f32_16x16x32_bf16 v[108:111], a[184:187], a[32:35], v[108:111]
    ds_read_b128 a[172:175], v15 offset:1024
    v_add_lshl_u32 v71, v71, v74, 4
    v_mfma_f32_16x16x32_bf16 v[108:111], a[188:191], a[36:39], v[108:111]
    v_add_u32 v158, s101, v71
    v_and_b32 v71, 12, v74
    v_mfma_f32_16x16x32_bf16 v[92:95], a[192:195], a[24:27], v[92:95]
    v_add_u32 v74, v74, v71
    buffer_load_dwordx4 a[96:99], v58, s[8:11], s78 offen offset:2048 sc1
    v_mfma_f32_16x16x32_bf16 v[92:95], a[196:199], a[28:31], v[92:95]
    ds_read_b128 a[176:179], v14 offset:2048
    v_mul_u32_u24 v74, 2560, v74
    v_mfma_f32_16x16x32_bf16 v[112:115], a[192:195], a[32:35], v[112:115]
    ds_read_b128 a[180:183], v15 offset:2048
    v_lshl_add_u32 v152, v73, 4, v74
    v_mfma_f32_16x16x32_bf16 v[112:115], a[196:199], a[36:39], v[112:115]
    v_lshlrev_b32 v128, 16, v236
    s_waitcnt vmcnt(12) lgkmcnt(2)
    v_mfma_f32_16x16x32_bf16 v[76:79], a[160:163], a[40:43], v[76:79]
    v_and_b32 v129, 0xffff0000, v236
    v_lshlrev_b32 v130, 16, v237
    v_mfma_f32_16x16x32_bf16 v[76:79], a[164:167], a[44:47], v[76:79]
    ds_read_b128 a[184:187], v14 offset:3072
    buffer_load_dwordx4 a[100:103], v58, s[8:11], s78 offen offset:3072 sc1
    v_mfma_f32_16x16x32_bf16 v[96:99], a[160:163], a[48:51], v[96:99]
    ds_read_b128 a[188:191], v15 offset:3072
    v_and_b32 v131, 0xffff0000, v237
    v_mfma_f32_16x16x32_bf16 v[96:99], a[164:167], a[52:55], v[96:99]
    v_lshlrev_b32 v132, 16, v238
    v_and_b32 v133, 0xffff0000, v238
    v_mfma_f32_16x16x32_bf16 v[80:83], a[168:171], a[40:43], v[80:83]
    v_lshlrev_b32 v134, 16, v239
    v_and_b32 v135, 0xffff0000, v239
    v_mfma_f32_16x16x32_bf16 v[80:83], a[172:175], a[44:47], v[80:83]
    ds_read_b128 a[192:195], v14 offset:4096
    v_lshlrev_b32 v136, 16, v240
    v_mfma_f32_16x16x32_bf16 v[100:103], a[168:171], a[48:51], v[100:103]
    ds_read_b128 a[196:199], v15 offset:4096
    buffer_load_dwordx4 v55, s[20:23], s69 offen offset:3072 sc1 lds
    v_mfma_f32_16x16x32_bf16 v[100:103], a[172:175], a[52:55], v[100:103]
    v_and_b32 v137, 0xffff0000, v240
    s_waitcnt lgkmcnt(2)
    v_mfma_f32_16x16x32_bf16 v[84:87], a[176:179], a[40:43], v[84:87]
    v_lshlrev_b32 v138, 16, v241
    v_and_b32 v139, 0xffff0000, v241
    v_mfma_f32_16x16x32_bf16 v[84:87], a[180:183], a[44:47], v[84:87]
    ds_read_b128 a[160:163], v14 offset:10240
    v_lshlrev_b32 v140, 16, v242
    v_mfma_f32_16x16x32_bf16 v[104:107], a[176:179], a[48:51], v[104:107]
    ds_read_b128 a[164:167], v15 offset:10240
    s_add_u32 m0, s45, 4096
    s_nop 0
    buffer_load_dwordx4 v56, s[20:23], s69 offen sc1 lds
    v_mfma_f32_16x16x32_bf16 v[104:107], a[180:183], a[52:55], v[104:107]
    v_and_b32 v141, 0xffff0000, v242
    v_lshlrev_b32 v142, 16, v243
    v_mfma_f32_16x16x32_bf16 v[88:91], a[184:187], a[40:43], v[88:91]
    v_and_b32 v143, 0xffff0000, v243
    v_lshlrev_b32 v144, 16, v244
    v_mfma_f32_16x16x32_bf16 v[88:91], a[188:191], a[44:47], v[88:91]
    ds_read_b128 a[168:171], v14 offset:11264
    v_and_b32 v145, 0xffff0000, v244
    v_mfma_f32_16x16x32_bf16 v[108:111], a[184:187], a[48:51], v[108:111]
    ds_read_b128 a[172:175], v15 offset:11264
    buffer_load_dwordx4 a[104:107], v57, s[8:11], s79 offen offset:0 sc1
    v_mfma_f32_16x16x32_bf16 v[108:111], a[188:191], a[52:55], v[108:111]
    v_lshlrev_b32 v146, 16, v245
    s_waitcnt lgkmcnt(2)
    v_mfma_f32_16x16x32_bf16 v[92:95], a[192:195], a[40:43], v[92:95]
    v_and_b32 v147, 0xffff0000, v245
    v_lshlrev_b32 v71, 16, v246
    v_mfma_f32_16x16x32_bf16 v[92:95], a[196:199], a[44:47], v[92:95]
    ds_read_b128 a[176:179], v14 offset:12288
    v_lshlrev_b32 v72, 16, v116
    v_mfma_f32_16x16x32_bf16 v[112:115], a[192:195], a[48:51], v[112:115]
    ds_read_b128 a[180:183], v15 offset:12288
    v_and_b32 v73, 0xffff0000, v246
    buffer_load_dwordx4 a[108:111], v57, s[8:11], s79 offen offset:1024 sc1
    v_mfma_f32_16x16x32_bf16 v[112:115], a[196:199], a[52:55], v[112:115]
    v_and_b32 v74, 0xffff0000, v116
    s_waitcnt vmcnt(12)
    v_mfma_f32_16x16x32_bf16 v[76:79], a[160:163], a[56:59], v[76:79]
    v_mul_f32 v160, v71, v72
    v_mul_f32 v161, v73, v74
    v_mfma_f32_16x16x32_bf16 v[76:79], a[164:167], a[60:63], v[76:79]
    ds_read_b128 a[184:187], v14 offset:13312
    v_lshlrev_b32 v71, 16, v247
    v_mfma_f32_16x16x32_bf16 v[96:99], a[160:163], a[64:67], v[96:99]
    ds_read_b128 a[188:191], v15 offset:13312
    v_lshlrev_b32 v72, 16, v117
    v_mfma_f32_16x16x32_bf16 v[96:99], a[164:167], a[68:71], v[96:99]
    buffer_load_dwordx4 a[112:115], v58, s[8:11], s79 offen offset:0 sc1
    s_waitcnt lgkmcnt(2)
    v_mfma_f32_16x16x32_bf16 v[80:83], a[168:171], a[56:59], v[80:83]
    v_and_b32 v73, 0xffff0000, v247
    v_and_b32 v74, 0xffff0000, v117
    v_mfma_f32_16x16x32_bf16 v[80:83], a[172:175], a[60:63], v[80:83]
    ds_read_b128 a[192:195], v14 offset:14336
    v_mul_f32 v162, v71, v72
    v_mfma_f32_16x16x32_bf16 v[100:103], a[168:171], a[64:67], v[100:103]
    ds_read_b128 a[196:199], v15 offset:14336
    v_mul_f32 v163, v73, v74
    v_mfma_f32_16x16x32_bf16 v[100:103], a[172:175], a[68:71], v[100:103]
    buffer_load_dwordx4 a[116:119], v58, s[8:11], s79 offen offset:1024 sc1
    v_lshlrev_b32 v71, 16, v248
    v_mfma_f32_16x16x32_bf16 v[84:87], a[176:179], a[56:59], v[84:87]
    v_lshlrev_b32 v72, 16, v118
    v_and_b32 v73, 0xffff0000, v248
    v_mfma_f32_16x16x32_bf16 v[84:87], a[180:183], a[60:63], v[84:87]
    s_barrier
    ds_read_b128 a[160:163], v14 offset:20480
    v_mfma_f32_16x16x32_bf16 v[104:107], a[176:179], a[64:67], v[104:107]
    ds_read_b128 a[164:167], v15 offset:20480
    buffer_load_dwordx4 a[120:123], v57, s[8:11], s79 offen offset:2048 sc1
    v_mfma_f32_16x16x32_bf16 v[104:107], a[180:183], a[68:71], v[104:107]
    v_and_b32 v74, 0xffff0000, v118
    s_waitcnt lgkmcnt(2)
    v_mfma_f32_16x16x32_bf16 v[88:91], a[184:187], a[56:59], v[88:91]
    v_mul_f32 v164, v71, v72
    v_mul_f32 v165, v73, v74
    v_mfma_f32_16x16x32_bf16 v[88:91], a[188:191], a[60:63], v[88:91]
    ds_read_b128 a[168:171], v14 offset:21504
    buffer_load_dwordx4 a[124:127], v57, s[8:11], s79 offen offset:3072 sc1
    v_mfma_f32_16x16x32_bf16 v[108:111], a[184:187], a[64:67], v[108:111]
    ds_read_b128 a[172:175], v15 offset:21504
    v_lshlrev_b32 v71, 16, v249
    v_mfma_f32_16x16x32_bf16 v[108:111], a[188:191], a[68:71], v[108:111]
    v_lshlrev_b32 v72, 16, v119
    v_and_b32 v73, 0xffff0000, v249
    v_mfma_f32_16x16x32_bf16 v[92:95], a[192:195], a[56:59], v[92:95]
    v_and_b32 v74, 0xffff0000, v119
    v_mul_f32 v166, v71, v72
    v_mfma_f32_16x16x32_bf16 v[92:95], a[196:199], a[60:63], v[92:95]
    ds_read_b128 a[176:179], v14 offset:22528
    buffer_load_dwordx4 a[128:131], v58, s[8:11], s79 offen offset:2048 sc1
    v_mfma_f32_16x16x32_bf16 v[112:115], a[192:195], a[64:67], v[112:115]
    ds_read_b128 a[180:183], v15 offset:22528
    v_mul_f32 v167, v73, v74
    v_mfma_f32_16x16x32_bf16 v[112:115], a[196:199], a[68:71], v[112:115]
    v_lshlrev_b32 v71, 16, v250
    s_waitcnt vmcnt(13) lgkmcnt(2)
    v_mfma_f32_16x16x32_bf16 v[76:79], a[160:163], a[72:75], v[76:79]
    v_lshlrev_b32 v72, 16, v120
    v_and_b32 v73, 0xffff0000, v250
    v_mfma_f32_16x16x32_bf16 v[76:79], a[164:167], a[76:79], v[76:79]
    ds_read_b128 a[184:187], v14 offset:23552
    v_and_b32 v74, 0xffff0000, v120
    buffer_load_dwordx4 a[132:135], v58, s[8:11], s79 offen offset:3072 sc1
    v_mfma_f32_16x16x32_bf16 v[96:99], a[160:163], a[80:83], v[96:99]
    ds_read_b128 a[188:191], v15 offset:23552
    v_mul_f32 v168, v71, v72
    v_mfma_f32_16x16x32_bf16 v[96:99], a[164:167], a[84:87], v[96:99]
    v_mul_f32 v169, v73, v74
    v_lshlrev_b32 v71, 16, v251
    v_mfma_f32_16x16x32_bf16 v[80:83], a[168:171], a[72:75], v[80:83]
    v_lshlrev_b32 v72, 16, v121
    v_and_b32 v73, 0xffff0000, v251
    v_mfma_f32_16x16x32_bf16 v[80:83], a[172:175], a[76:79], v[80:83]
    ds_read_b128 a[192:195], v14 offset:24576
    v_and_b32 v74, 0xffff0000, v121
    v_mfma_f32_16x16x32_bf16 v[100:103], a[168:171], a[80:83], v[100:103]
    ds_read_b128 a[196:199], v15 offset:24576
    s_add_u32 m0, s45, 20480
    s_nop 0
    buffer_load_dwordx4 v52, s[20:23], s70 offen sc1 lds
    v_mfma_f32_16x16x32_bf16 v[100:103], a[172:175], a[84:87], v[100:103]
    v_mul_f32 v170, v71, v72
    s_waitcnt lgkmcnt(2)
    v_mfma_f32_16x16x32_bf16 v[84:87], a[176:179], a[72:75], v[84:87]
    v_mul_f32 v171, v73, v74
    v_lshlrev_b32 v71, 16, v252
    v_mfma_f32_16x16x32_bf16 v[84:87], a[180:183], a[76:79], v[84:87]
    ds_read_b128 a[160:163], v14 offset:30720
    v_lshlrev_b32 v72, 16, v122
    v_mfma_f32_16x16x32_bf16 v[104:107], a[176:179], a[80:83], v[104:107]
    ds_read_b128 a[164:167], v15 offset:30720
    buffer_load_dwordx4 v53, s[20:23], s70 offen offset:1024 sc1 lds
    v_mfma_f32_16x16x32_bf16 v[104:107], a[180:183], a[84:87], v[104:107]
    v_and_b32 v73, 0xffff0000, v252
    v_and_b32 v74, 0xffff0000, v122
    v_mfma_f32_16x16x32_bf16 v[88:91], a[184:187], a[72:75], v[88:91]
    v_mul_f32 v172, v71, v72
    v_mul_f32 v173, v73, v74
    v_mfma_f32_16x16x32_bf16 v[88:91], a[188:191], a[76:79], v[88:91]
    ds_read_b128 a[168:171], v14 offset:31744
    s_add_u32 s0, s95, 208896
    v_mfma_f32_16x16x32_bf16 v[108:111], a[184:187], a[80:83], v[108:111]
    ds_read_b128 a[172:175], v15 offset:31744
    buffer_load_dword v212, v68, s[8:11], s0 offen offset:0 sc1
    buffer_load_dwordx4 v54, s[20:23], s70 offen offset:2048 sc1 lds
    v_mfma_f32_16x16x32_bf16 v[108:111], a[188:191], a[84:87], v[108:111]
    v_lshlrev_b32 v71, 16, v253
    s_waitcnt lgkmcnt(2)
    v_mfma_f32_16x16x32_bf16 v[92:95], a[192:195], a[72:75], v[92:95]
    v_lshlrev_b32 v72, 16, v123
    v_and_b32 v73, 0xffff0000, v253
    v_mfma_f32_16x16x32_bf16 v[92:95], a[196:199], a[76:79], v[92:95]
    ds_read_b128 a[176:179], v14 offset:32768
    v_and_b32 v74, 0xffff0000, v123
    v_mfma_f32_16x16x32_bf16 v[112:115], a[192:195], a[80:83], v[112:115]
    ds_read_b128 a[180:183], v15 offset:32768
    buffer_load_dwordx4 v55, s[20:23], s70 offen offset:3072 sc1 lds
    v_mfma_f32_16x16x32_bf16 v[112:115], a[196:199], a[84:87], v[112:115]
    v_mul_f32 v174, v71, v72
    s_waitcnt vmcnt(15)
    v_mfma_f32_16x16x32_bf16 v[76:79], a[160:163], a[88:91], v[76:79]
    v_mul_f32 v175, v73, v74
    v_lshlrev_b32 v71, 16, v254
    v_mfma_f32_16x16x32_bf16 v[76:79], a[164:167], a[92:95], v[76:79]
    ds_read_b128 a[184:187], v14 offset:33792
    v_lshlrev_b32 v72, 16, v124
    v_mfma_f32_16x16x32_bf16 v[96:99], a[160:163], a[96:99], v[96:99]
    ds_read_b128 a[188:191], v15 offset:33792
    v_and_b32 v73, 0xffff0000, v254
    s_add_u32 m0, s45, 24576
    v_mfma_f32_16x16x32_bf16 v[96:99], a[164:167], a[100:103], v[96:99]
    buffer_load_dwordx4 v56, s[20:23], s70 offen sc1 lds
    s_waitcnt lgkmcnt(2)
    v_mfma_f32_16x16x32_bf16 v[80:83], a[168:171], a[88:91], v[80:83]
    v_and_b32 v74, 0xffff0000, v124
    v_mul_f32 v176, v71, v72
    v_mfma_f32_16x16x32_bf16 v[80:83], a[172:175], a[92:95], v[80:83]
    ds_read_b128 a[192:195], v14 offset:34816
    v_mul_f32 v177, v73, v74
    v_mfma_f32_16x16x32_bf16 v[100:103], a[168:171], a[96:99], v[100:103]
    ds_read_b128 a[196:199], v15 offset:34816
    v_lshlrev_b32 v71, 16, v255
    v_mfma_f32_16x16x32_bf16 v[100:103], a[172:175], a[100:103], v[100:103]
    buffer_load_dwordx4 a[136:139], v57, s[8:11], s80 offen offset:0 sc1
    v_lshlrev_b32 v72, 16, v125
    v_mfma_f32_16x16x32_bf16 v[84:87], a[176:179], a[88:91], v[84:87]
    v_and_b32 v73, 0xffff0000, v255
    v_and_b32 v74, 0xffff0000, v125
    v_mfma_f32_16x16x32_bf16 v[84:87], a[180:183], a[92:95], v[84:87]
    s_waitcnt vmcnt(15)
    s_barrier
    ds_read_b128 a[160:163], v59 offset:0
    v_mfma_f32_16x16x32_bf16 v[104:107], a[176:179], a[96:99], v[104:107]
    ds_read_b128 a[164:167], v60 offset:0
    buffer_load_dwordx4 a[140:143], v57, s[8:11], s80 offen offset:1024 sc1
    v_mfma_f32_16x16x32_bf16 v[104:107], a[180:183], a[100:103], v[104:107]
    v_mul_f32 v178, v71, v72
    s_waitcnt lgkmcnt(2)
    v_mfma_f32_16x16x32_bf16 v[88:91], a[184:187], a[88:91], v[88:91]
    v_mul_f32 v179, v73, v74
    v_mfma_f32_16x16x32_bf16 v[88:91], a[188:191], a[92:95], v[88:91]
    ds_read_b128 a[168:171], v59 offset:1024
    buffer_load_dwordx4 a[144:147], v58, s[8:11], s80 offen offset:0 sc1
    v_mfma_f32_16x16x32_bf16 v[108:111], a[184:187], a[96:99], v[108:111]
    ds_read_b128 a[172:175], v60 offset:1024
    v_mfma_f32_16x16x32_bf16 v[108:111], a[188:191], a[100:103], v[108:111]
    v_mfma_f32_16x16x32_bf16 v[92:95], a[192:195], a[88:91], v[92:95]
    v_mfma_f32_16x16x32_bf16 v[92:95], a[196:199], a[92:95], v[92:95]
    ds_read_b128 a[176:179], v59 offset:2048
    buffer_load_dwordx4 a[148:151], v58, s[8:11], s80 offen offset:1024 sc1
    v_mfma_f32_16x16x32_bf16 v[112:115], a[192:195], a[96:99], v[112:115]
    ds_read_b128 a[180:183], v60 offset:2048
    v_mfma_f32_16x16x32_bf16 v[112:115], a[196:199], a[100:103], v[112:115]
    s_waitcnt vmcnt(14) lgkmcnt(2)
    v_mfma_f32_16x16x32_bf16 v[76:79], a[160:163], a[104:107], v[76:79]
    v_mfma_f32_16x16x32_bf16 v[76:79], a[164:167], a[108:111], v[76:79]
    ds_read_b128 a[184:187], v59 offset:3072
    buffer_load_dwordx4 a[152:155], v57, s[8:11], s80 offen offset:2048 sc1
    v_mfma_f32_16x16x32_bf16 v[96:99], a[160:163], a[112:115], v[96:99]
    ds_read_b128 a[188:191], v60 offset:3072
    v_mfma_f32_16x16x32_bf16 v[96:99], a[164:167], a[116:119], v[96:99]
    v_mfma_f32_16x16x32_bf16 v[80:83], a[168:171], a[104:107], v[80:83]
    v_mfma_f32_16x16x32_bf16 v[80:83], a[172:175], a[108:111], v[80:83]
    ds_read_b128 a[192:195], v59 offset:4096
    v_mfma_f32_16x16x32_bf16 v[100:103], a[168:171], a[112:115], v[100:103]
    ds_read_b128 a[196:199], v60 offset:4096
    buffer_load_dwordx4 a[156:159], v57, s[8:11], s80 offen offset:3072 sc1
    v_mfma_f32_16x16x32_bf16 v[100:103], a[172:175], a[116:119], v[100:103]
    s_waitcnt lgkmcnt(2)
    v_mfma_f32_16x16x32_bf16 v[84:87], a[176:179], a[104:107], v[84:87]
    s_waitcnt vmcnt(9)
    v_cmp_ne_u32 vcc, s42, v212
    s_cbranch_vccnz L_slow6
L_ok6:
    v_mfma_f32_16x16x32_bf16 v[84:87], a[180:183], a[108:111], v[84:87]
    ds_read_b128 a[160:163], v59 offset:10240
    v_mfma_f32_16x16x32_bf16 v[104:107], a[176:179], a[112:115], v[104:107]
    ds_read_b128 a[164:167], v60 offset:10240
    v_mfma_f32_16x16x32_bf16 v[104:107], a[180:183], a[116:119], v[104:107]
    v_mfma_f32_16x16x32_bf16 v[88:91], a[184:187], a[104:107], v[88:91]
    buffer_load_dwordx4 a[200:203], v58, s[8:11], s80 offen offset:2048 sc1
    v_mfma_f32_16x16x32_bf16 v[88:91], a[188:191], a[108:111], v[88:91]
    ds_read_b128 a[168:171], v59 offset:11264
    v_mfma_f32_16x16x32_bf16 v[108:111], a[184:187], a[112:115], v[108:111]
    ds_read_b128 a[172:175], v60 offset:11264
    v_mfma_f32_16x16x32_bf16 v[108:111], a[188:191], a[116:119], v[108:111]
    s_waitcnt lgkmcnt(2)
    v_mfma_f32_16x16x32_bf16 v[92:95], a[192:195], a[104:107], v[92:95]
    buffer_load_dwordx4 a[204:207], v58, s[8:11], s80 offen offset:3072 sc1
    v_mfma_f32_16x16x32_bf16 v[92:95], a[196:199], a[108:111], v[92:95]
    ds_read_b128 a[176:179], v59 offset:12288
    v_mfma_f32_16x16x32_bf16 v[112:115], a[192:195], a[112:115], v[112:115]
    ds_read_b128 a[180:183], v60 offset:12288
    v_mfma_f32_16x16x32_bf16 v[112:115], a[196:199], a[116:119], v[112:115]
    v_mfma_f32_16x16x32_bf16 v[76:79], a[160:163], a[120:123], v[76:79]
    v_mfma_f32_16x16x32_bf16 v[76:79], a[164:167], a[124:127], v[76:79]
    ds_read_b128 a[184:187], v59 offset:13312
    s_add_u32 m0, s45, 40960
    s_nop 0
    buffer_load_dwordx4 v52, s[16:19], s71 offen sc1 lds
    v_mfma_f32_16x16x32_bf16 v[96:99], a[160:163], a[128:131], v[96:99]
    ds_read_b128 a[188:191], v60 offset:13312
    v_mfma_f32_16x16x32_bf16 v[96:99], a[164:167], a[132:135], v[96:99]
    s_waitcnt lgkmcnt(2)
    v_mfma_f32_16x16x32_bf16 v[80:83], a[168:171], a[120:123], v[80:83]
    v_mfma_f32_16x16x32_bf16 v[80:83], a[172:175], a[124:127], v[80:83]
    ds_read_b128 a[192:195], v59 offset:14336
    buffer_load_dwordx4 v53, s[16:19], s71 offen offset:1024 sc1 lds
    v_mfma_f32_16x16x32_bf16 v[100:103], a[168:171], a[128:131], v[100:103]
    ds_read_b128 a[196:199], v60 offset:14336
    v_mfma_f32_16x16x32_bf16 v[100:103], a[172:175], a[132:135], v[100:103]
L_pad5:
    s_cbranch_execz L_back
    v_mfma_f32_16x16x32_bf16 v[84:87], a[176:179], a[120:123], v[84:87]
    v_mfma_f32_16x16x32_bf16 v[84:87], a[180:183], a[124:127], v[84:87]
    buffer_load_dwordx4 v54, s[16:19], s71 offen offset:2048 sc1 lds
    s_waitcnt vmcnt(11)
    s_barrier
    ds_read_b128 a[160:163], v59 offset:20480
    v_mfma_f32_16x16x32_bf16 v[104:107], a[176:179], a[128:131], v[104:107]
    ds_read_b128 a[164:167], v60 offset:20480
    buffer_load_dwordx4 v55, s[16:19], s71 offen offset:3072 sc1 lds
    v_mfma_f32_16x16x32_bf16 v[104:107], a[180:183], a[132:135], v[104:107]
    s_waitcnt lgkmcnt(2)
    v_mfma_f32_16x16x32_bf16 v[88:91], a[184:187], a[120:123], v[88:91]
    v_mfma_f32_16x16x32_bf16 v[88:91], a[188:191], a[124:127], v[88:91]
    ds_read_b128 a[168:171], v59 offset:21504
    v_mfma_f32_16x16x32_bf16 v[108:111], a[184:187], a[128:131], v[108:111]
    ds_read_b128 a[172:175], v60 offset:21504
    s_add_u32 m0, s45, 45056
    s_nop 0
    buffer_load_dwordx4 v56, s[16:19], s71 offen sc1 lds
    v_mfma_f32_16x16x32_bf16 v[108:111], a[188:191], a[132:135], v[108:111]
    v_mfma_f32_16x16x32_bf16 v[92:95], a[192:195], a[120:123], v[92:95]
    v_mfma_f32_16x16x32_bf16 v[92:95], a[196:199], a[124:127], v[92:95]
    ds_read_b128 a[176:179], v59 offset:22528
    v_mfma_f32_16x16x32_bf16 v[112:115], a[192:195], a[128:131], v[112:115]
    ds_read_b128 a[180:183], v60 offset:22528
    buffer_load_dwordx4 a[208:211], v58, s[8:11], s81 offen offset:0 sc1
    v_mfma_f32_16x16x32_bf16 v[112:115], a[196:199], a[132:135], v[112:115]
    buffer_load_dwordx4 a[212:215], v58, s[8:11], s81 offen offset:1024 sc1
    s_waitcnt vmcnt(11) lgkmcnt(2)
    v_mfma_f32_16x16x32_bf16 v[76:79], a[160:163], a[136:139], v[76:79]
    v_mfma_f32_16x16x32_bf16 v[76:79], a[164:167], a[140:143], v[76:79]
    ds_read_b128 a[184:187], v59 offset:23552
    v_mfma_f32_16x16x32_bf16 v[96:99], a[160:163], a[144:147], v[96:99]
    ds_read_b128 a[188:191], v60 offset:23552
    v_mfma_f32_16x16x32_bf16 v[96:99], a[164:167], a[148:151], v[96:99]
    v_mfma_f32_16x16x32_bf16 v[80:83], a[168:171], a[136:139], v[80:83]
    buffer_load_dwordx4 a[216:219], v58, s[8:11], s81 offen offset:2048 sc1
    v_mfma_f32_16x16x32_bf16 v[80:83], a[172:175], a[140:143], v[80:83]
    ds_read_b128 a[192:195], v59 offset:24576
    v_mfma_f32_16x16x32_bf16 v[100:103], a[168:171], a[144:147], v[100:103]
    ds_read_b128 a[196:199], v60 offset:24576
    v_mfma_f32_16x16x32_bf16 v[100:103], a[172:175], a[148:151], v[100:103]
    s_waitcnt lgkmcnt(2)
    v_mfma_f32_16x16x32_bf16 v[84:87], a[176:179], a[136:139], v[84:87]
    buffer_load_dwordx4 a[220:223], v58, s[8:11], s81 offen offset:3072 sc1
    v_mfma_f32_16x16x32_bf16 v[84:87], a[180:183], a[140:143], v[84:87]
    ds_read_b128 a[160:163], v59 offset:30720
    v_mfma_f32_16x16x32_bf16 v[104:107], a[176:179], a[144:147], v[104:107]
    ds_read_b128 a[164:167], v60 offset:30720
    v_mfma_f32_16x16x32_bf16 v[104:107], a[180:183], a[148:151], v[104:107]
    v_mfma_f32_16x16x32_bf16 v[88:91], a[184:187], a[136:139], v[88:91]
    v_mfma_f32_16x16x32_bf16 v[88:91], a[188:191], a[140:143], v[88:91]
    ds_read_b128 a[168:171], v59 offset:31744
    s_add_u32 m0, s45, 61440
    s_nop 0
    buffer_load_dwordx4 v52, s[16:19], s72 offen sc1 lds
    v_mfma_f32_16x16x32_bf16 v[108:111], a[184:187], a[144:147], v[108:111]
    ds_read_b128 a[172:175], v60 offset:31744
    v_mfma_f32_16x16x32_bf16 v[108:111], a[188:191], a[148:151], v[108:111]
    s_waitcnt lgkmcnt(2)
    v_mfma_f32_16x16x32_bf16 v[92:95], a[192:195], a[136:139], v[92:95]
    v_mfma_f32_16x16x32_bf16 v[92:95], a[196:199], a[140:143], v[92:95]
    ds_read_b128 a[176:179], v59 offset:32768
    buffer_load_dwordx4 v53, s[16:19], s72 offen offset:1024 sc1 lds
    v_mfma_f32_16x16x32_bf16 v[112:115], a[192:195], a[144:147], v[112:115]
    ds_read_b128 a[180:183], v60 offset:32768
    v_mfma_f32_16x16x32_bf16 v[112:115], a[196:199], a[148:151], v[112:115]
    s_waitcnt vmcnt(11)
    v_mfma_f32_16x16x32_bf16 v[76:79], a[160:163], a[152:155], v[76:79]
    v_mfma_f32_16x16x32_bf16 v[76:79], a[164:167], a[156:159], v[76:79]
    ds_read_b128 a[184:187], v59 offset:33792
    buffer_load_dwordx4 v54, s[16:19], s72 offen offset:2048 sc1 lds
    v_mfma_f32_16x16x32_bf16 v[96:99], a[160:163], a[200:203], v[96:99]
    ds_read_b128 a[188:191], v60 offset:33792
    v_mfma_f32_16x16x32_bf16 v[96:99], a[164:167], a[204:207], v[96:99]
    s_waitcnt lgkmcnt(2)
    v_mfma_f32_16x16x32_bf16 v[80:83], a[168:171], a[152:155], v[80:83]
    v_mfma_f32_16x16x32_bf16 v[80:83], a[172:175], a[156:159], v[80:83]
    ds_read_b128 a[192:195], v59 offset:34816
    buffer_load_dwordx4 v55, s[16:19], s72 offen offset:3072 sc1 lds
    v_mfma_f32_16x16x32_bf16 v[100:103], a[168:171], a[200:203], v[100:103]
    ds_read_b128 a[196:199], v60 offset:34816
    v_mfma_f32_16x16x32_bf16 v[100:103], a[172:175], a[204:207], v[100:103]
    v_mfma_f32_16x16x32_bf16 v[84:87], a[176:179], a[152:155], v[84:87]
    v_mfma_f32_16x16x32_bf16 v[84:87], a[180:183], a[156:159], v[84:87]
    s_add_u32 m0, s45, 65536
    s_nop 0
    buffer_load_dwordx4 v56, s[16:19], s72 offen sc1 lds
    buffer_load_dwordx4 a[224:227], v58, s[8:11], s82 offen offset:0 sc1
    buffer_load_dwordx4 a[228:231], v58, s[8:11], s82 offen offset:1024 sc1
    s_waitcnt vmcnt(11)
    s_barrier
    ds_read_b128 a[160:163], v59 offset:40960
    v_mfma_f32_16x16x32_bf16 v[104:107], a[176:179], a[200:203], v[104:107]
    ds_read_b128 a[164:167], v60 offset:40960
    buffer_load_dwordx4 a[232:235], v58, s[8:11], s82 offen offset:2048 sc1
    v_mfma_f32_16x16x32_bf16 v[104:107], a[180:183], a[204:207], v[104:107]
    ds_read_b128 a[168:171], v59 offset:41984
    s_waitcnt lgkmcnt(3)
    v_mfma_f32_16x16x32_bf16 v[88:91], a[184:187], a[152:155], v[88:91]
    ds_read_b128 a[172:175], v60 offset:41984
    v_mfma_f32_16x16x32_bf16 v[88:91], a[188:191], a[156:159], v[88:91]
    ds_read_b128 a[176:179], v59 offset:43008
    v_mfma_f32_16x16x32_bf16 v[108:111], a[184:187], a[200:203], v[108:111]
    ds_read_b128 a[180:183], v60 offset:43008
    v_mfma_f32_16x16x32_bf16 v[108:111], a[188:191], a[204:207], v[108:111]
    ds_read_b128 a[184:187], v59 offset:44032
    buffer_load_dwordx4 a[236:239], v58, s[8:11], s82 offen offset:3072 sc1
    v_mfma_f32_16x16x32_bf16 v[92:95], a[192:195], a[152:155], v[92:95]
    ds_read_b128 a[188:191], v60 offset:44032
    v_mfma_f32_16x16x32_bf16 v[92:95], a[196:199], a[156:159], v[92:95]
    v_mfma_f32_16x16x32_bf16 v[112:115], a[192:195], a[200:203], v[112:115]
    ds_read_b128 a[192:195], v59 offset:45056
    v_mfma_f32_16x16x32_bf16 v[112:115], a[196:199], a[204:207], v[112:115]
    ds_read_b128 a[196:199], v60 offset:45056
    s_add_u32 m0, s45, 81920
    s_waitcnt vmcnt(11) lgkmcnt(6)
    v_mfma_f32_16x16x32_bf16 v[96:99], a[160:163], a[208:211], v[96:99]
    buffer_load_dwordx4 v52, s[16:19], s73 offen sc1 lds
    v_mfma_f32_16x16x32_bf16 v[96:99], a[164:167], a[212:215], v[96:99]
    ds_read_b128 a[160:163], v59 offset:51200
    v_mfma_f32_16x16x32_bf16 v[100:103], a[168:171], a[208:211], v[100:103]
    ds_read_b128 a[164:167], v60 offset:51200
    v_mfma_f32_16x16x32_bf16 v[100:103], a[172:175], a[212:215], v[100:103]
    ds_read_b128 a[168:171], v59 offset:52224
    buffer_load_dwordx4 v53, s[16:19], s73 offen offset:1024 sc1 lds
    s_waitcnt lgkmcnt(5)
    v_mfma_f32_16x16x32_bf16 v[104:107], a[176:179], a[208:211], v[104:107]
    ds_read_b128 a[172:175], v60 offset:52224
    v_mfma_f32_16x16x32_bf16 v[104:107], a[180:183], a[212:215], v[104:107]
    ds_read_b128 a[176:179], v59 offset:53248
    v_mfma_f32_16x16x32_bf16 v[108:111], a[184:187], a[208:211], v[108:111]
    ds_read_b128 a[180:183], v60 offset:53248
    v_mfma_f32_16x16x32_bf16 v[108:111], a[188:191], a[212:215], v[108:111]
    ds_read_b128 a[184:187], v59 offset:54272
    buffer_load_dwordx4 v54, s[16:19], s73 offen offset:2048 sc1 lds
    s_waitcnt lgkmcnt(5)
    v_mfma_f32_16x16x32_bf16 v[112:115], a[192:195], a[208:211], v[112:115]
    ds_read_b128 a[188:191], v60 offset:54272
    v_mfma_f32_16x16x32_bf16 v[112:115], a[196:199], a[212:215], v[112:115]
    ds_read_b128 a[192:195], v59 offset:55296
    s_waitcnt vmcnt(12)
    v_mfma_f32_16x16x32_bf16 v[96:99], a[160:163], a[216:219], v[96:99]
    ds_read_b128 a[196:199], v60 offset:55296
    buffer_load_dwordx4 v55, s[16:19], s73 offen offset:3072 sc1 lds
    v_mfma_f32_16x16x32_bf16 v[96:99], a[164:167], a[220:223], v[96:99]
    s_add_u32 m0, s45, 86016
    s_nop 0
    buffer_load_dwordx4 v56, s[16:19], s73 offen sc1 lds
    buffer_load_dwordx4 a[240:243], v58, s[8:11], s83 offen offset:0 sc1
    buffer_load_dwordx4 a[244:247], v58, s[8:11], s83 offen offset:1024 sc1
    s_waitcnt vmcnt(11)
    s_barrier
    ds_read_b128 a[160:163], v16 offset:0
    s_waitcnt lgkmcnt(5)
    v_mfma_f32_16x16x32_bf16 v[100:103], a[168:171], a[216:219], v[100:103]
    ds_read_b128 a[164:167], v17 offset:0
    buffer_load_dwordx4 a[248:251], v58, s[8:11], s83 offen offset:2048 sc1
    v_mfma_f32_16x16x32_bf16 v[100:103], a[172:175], a[220:223], v[100:103]
    ds_read_b128 a[168:171], v16 offset:1024
    v_mfma_f32_16x16x32_bf16 v[104:107], a[176:179], a[216:219], v[104:107]
    ds_read_b128 a[172:175], v17 offset:1024
    v_mfma_f32_16x16x32_bf16 v[104:107], a[180:183], a[220:223], v[104:107]
    ds_read_b128 a[176:179], v16 offset:2048
    s_waitcnt lgkmcnt(5)
    v_mfma_f32_16x16x32_bf16 v[108:111], a[184:187], a[216:219], v[108:111]
    ds_read_b128 a[180:183], v17 offset:2048
    buffer_load_dwordx4 a[252:255], v58, s[8:11], s83 offen offset:3072 sc1
    v_mfma_f32_16x16x32_bf16 v[108:111], a[188:191], a[220:223], v[108:111]
    ds_read_b128 a[184:187], v16 offset:3072
    v_mfma_f32_16x16x32_bf16 v[112:115], a[192:195], a[216:219], v[112:115]
    ds_read_b128 a[188:191], v17 offset:3072
    v_mfma_f32_16x16x32_bf16 v[112:115], a[196:199], a[220:223], v[112:115]
    ds_read_b128 a[192:195], v16 offset:4096
    s_waitcnt vmcnt(11) lgkmcnt(5)
    v_mfma_f32_16x16x32_bf16 v[96:99], a[160:163], a[224:227], v[96:99]
    ds_read_b128 a[196:199], v17 offset:4096
    buffer_load_dwordx4 a[0:3], v57, s[8:11], s81 offen offset:0 sc1
    v_mfma_f32_16x16x32_bf16 v[96:99], a[164:167], a[228:231], v[96:99]
    ds_read_b128 a[160:163], v16 offset:10240
    v_mfma_f32_16x16x32_bf16 v[100:103], a[168:171], a[224:227], v[100:103]
    ds_read_b128 a[164:167], v17 offset:10240
    v_mfma_f32_16x16x32_bf16 v[100:103], a[172:175], a[228:231], v[100:103]
    ds_read_b128 a[168:171], v16 offset:11264
    buffer_load_dwordx4 a[4:7], v57, s[8:11], s81 offen offset:1024 sc1
    s_waitcnt lgkmcnt(5)
    v_mfma_f32_16x16x32_bf16 v[104:107], a[176:179], a[224:227], v[104:107]
    ds_read_b128 a[172:175], v17 offset:11264
    v_mfma_f32_16x16x32_bf16 v[104:107], a[180:183], a[228:231], v[104:107]
    ds_read_b128 a[176:179], v16 offset:12288
    v_mfma_f32_16x16x32_bf16 v[108:111], a[184:187], a[224:227], v[108:111]
    ds_read_b128 a[180:183], v17 offset:12288
    v_mfma_f32_16x16x32_bf16 v[108:111], a[188:191], a[228:231], v[108:111]
    ds_read_b128 a[184:187], v16 offset:13312
    buffer_load_dwordx4 a[8:11], v57, s[8:11], s81 offen offset:2048 sc1
    s_waitcnt lgkmcnt(5)
    v_mfma_f32_16x16x32_bf16 v[112:115], a[192:195], a[224:227], v[112:115]
    ds_read_b128 a[188:191], v17 offset:13312
    v_mfma_f32_16x16x32_bf16 v[112:115], a[196:199], a[228:231], v[112:115]
    ds_read_b128 a[192:195], v16 offset:14336
    s_waitcnt vmcnt(12)
    v_mfma_f32_16x16x32_bf16 v[96:99], a[160:163], a[232:235], v[96:99]
    ds_read_b128 a[196:199], v17 offset:14336
    v_mfma_f32_16x16x32_bf16 v[96:99], a[164:167], a[236:239], v[96:99]
    buffer_load_dwordx4 a[12:15], v57, s[8:11], s81 offen offset:3072 sc1
    buffer_load_dwordx4 a[16:19], v57, s[8:11], s82 offen offset:0 sc1
    buffer_load_dwordx4 a[20:23], v57, s[8:11], s82 offen offset:1024 sc1
    buffer_load_dwordx4 a[24:27], v57, s[8:11], s82 offen offset:2048 sc1
    s_waitcnt vmcnt(11)
    s_barrier
    ds_read_b128 a[160:163], v16 offset:20480
    s_waitcnt lgkmcnt(5)
    v_mfma_f32_16x16x32_bf16 v[100:103], a[168:171], a[232:235], v[100:103]
    ds_read_b128 a[164:167], v17 offset:20480
    buffer_load_dwordx4 a[28:31], v57, s[8:11], s82 offen offset:3072 sc1
    v_mfma_f32_16x16x32_bf16 v[100:103], a[172:175], a[236:239], v[100:103]
    ds_read_b128 a[168:171], v16 offset:21504
    v_mfma_f32_16x16x32_bf16 v[104:107], a[176:179], a[232:235], v[104:107]
    ds_read_b128 a[172:175], v17 offset:21504
    v_mfma_f32_16x16x32_bf16 v[104:107], a[180:183], a[236:239], v[104:107]
    ds_read_b128 a[176:179], v16 offset:22528
    s_waitcnt lgkmcnt(5)
    v_mfma_f32_16x16x32_bf16 v[108:111], a[184:187], a[232:235], v[108:111]
    ds_read_b128 a[180:183], v17 offset:22528
    buffer_load_dwordx4 a[32:35], v57, s[8:11], s83 offen offset:0 sc1
    v_mfma_f32_16x16x32_bf16 v[108:111], a[188:191], a[236:239], v[108:111]
    ds_read_b128 a[184:187], v16 offset:23552
    v_mfma_f32_16x16x32_bf16 v[112:115], a[192:195], a[232:235], v[112:115]
    ds_read_b128 a[188:191], v17 offset:23552
    v_mfma_f32_16x16x32_bf16 v[112:115], a[196:199], a[236:239], v[112:115]
    ds_read_b128 a[192:195], v16 offset:24576
    s_waitcnt vmcnt(11) lgkmcnt(5)
    v_mfma_f32_16x16x32_bf16 v[96:99], a[160:163], a[240:243], v[96:99]
    ds_read_b128 a[196:199], v17 offset:24576
    buffer_load_dwordx4 a[36:39], v57, s[8:11], s83 offen offset:1024 sc1
    v_mfma_f32_16x16x32_bf16 v[96:99], a[164:167], a[244:247], v[96:99]
    ds_read_b128 a[160:163], v16 offset:30720
    v_mfma_f32_16x16x32_bf16 v[100:103], a[168:171], a[240:243], v[100:103]
    ds_read_b128 a[164:167], v17 offset:30720
    v_mfma_f32_16x16x32_bf16 v[100:103], a[172:175], a[244:247], v[100:103]
    ds_read_b128 a[168:171], v16 offset:31744
    buffer_load_dwordx4 a[40:43], v57, s[8:11], s83 offen offset:2048 sc1
    s_waitcnt lgkmcnt(5)
    v_mfma_f32_16x16x32_bf16 v[104:107], a[176:179], a[240:243], v[104:107]
    ds_read_b128 a[172:175], v17 offset:31744
    v_mfma_f32_16x16x32_bf16 v[104:107], a[180:183], a[244:247], v[104:107]
    ds_read_b128 a[176:179], v16 offset:32768
    v_mfma_f32_16x16x32_bf16 v[108:111], a[184:187], a[240:243], v[108:111]
    ds_read_b128 a[180:183], v17 offset:32768
    v_mfma_f32_16x16x32_bf16 v[108:111], a[188:191], a[244:247], v[108:111]
    ds_read_b128 a[184:187], v16 offset:33792
    buffer_load_dwordx4 a[44:47], v57, s[8:11], s83 offen offset:3072 sc1
    s_waitcnt lgkmcnt(5)
    v_mfma_f32_16x16x32_bf16 v[112:115], a[192:195], a[240:243], v[112:115]
    ds_read_b128 a[188:191], v17 offset:33792
    s_lshl2_add_u32 s89, s2, s36
    s_mul_i32 s89, s89, 3072
    s_add_u32 s89, s89, 22151168
    v_mfma_f32_16x16x32_bf16 v[112:115], a[196:199], a[244:247], v[112:115]
    ds_read_b128 a[192:195], v16 offset:34816
    s_mov_b32 s30, 0xffff
    s_waitcnt vmcnt(12)
    v_mfma_f32_16x16x32_bf16 v[96:99], a[160:163], a[248:251], v[96:99]
    ds_read_b128 a[196:199], v17 offset:34816
    s_mov_b32 s28, 0xbfb8aa3b
    s_add_u32 m0, s45, 102400
    s_add_u32 s96, s48, 204800
    v_mfma_f32_16x16x32_bf16 v[96:99], a[164:167], a[252:255], v[96:99]
    ds_read_b128 a[160:163], v59 offset:40960
    s_max_i32 s51, s94, 0
    s_mul_i32 s51, s51, 20480
    s_add_u32 s96, s96, s51
    s_waitcnt lgkmcnt(5)
    v_mfma_f32_16x16x32_bf16 v[100:103], a[168:171], a[248:251], v[100:103]
    ds_read_b128 a[164:167], v60 offset:40960
    buffer_load_dwordx4 v1, s[8:11], s96 offen sc1 lds
    s_mov_b32 s29, 0xbfb8aa3b
    v_mfma_f32_16x16x32_bf16 v[100:103], a[172:175], a[252:255], v[100:103]
    ds_read_b128 a[168:171], v59 offset:41984
    v_cvt_pk_bf16_f32 v200, v96, v96
    v_cvt_pk_bf16_f32 v201, v97, v98
    v_mfma_f32_16x16x32_bf16 v[104:107], a[176:179], a[248:251], v[104:107]
    ds_read_b128 a[172:175], v60 offset:41984
    buffer_load_dwordx4 v1, s[8:11], s96 offen offset:1024 sc1 lds
    v_mfma_f32_16x16x32_bf16 v[104:107], a[180:183], a[252:255], v[104:107]
    ds_read_b128 a[176:179], v59 offset:43008
    v_cvt_pk_bf16_f32 v202, v99, v100
    s_waitcnt lgkmcnt(5)
    v_mfma_f32_16x16x32_bf16 v[108:111], a[184:187], a[248:251], v[108:111]
    ds_read_b128 a[180:183], v60 offset:43008
    v_cvt_pk_bf16_f32 v203, v101, v102
    v_bfi_b32 v200, s30, v21, v200
    v_mfma_f32_16x16x32_bf16 v[108:111], a[188:191], a[252:255], v[108:111]
    ds_read_b128 a[184:187], v59 offset:44032
    buffer_store_dwordx4 v[200:203], v1, s[8:11], s89 offen offset:0 sc1
    v_cvt_pk_bf16_f32 v204, v103, v103
    v_mfma_f32_16x16x32_bf16 v[112:115], a[192:195], a[248:251], v[112:115]
    ds_read_b128 a[188:191], v60 offset:44032
    v_cvt_pk_bf16_f32 v205, v104, v105
    v_cvt_pk_bf16_f32 v206, v106, v107
    v_mfma_f32_16x16x32_bf16 v[112:115], a[196:199], a[252:255], v[112:115]
    ds_read_b128 a[192:195], v59 offset:45056
    buffer_load_dwordx4 v1, s[8:11], s96 offen offset:2048 sc1 lds
    s_waitcnt vmcnt(14) lgkmcnt(5)
    v_mfma_f32_16x16x32_bf16 v[76:79], a[160:163], a[0:3], v[76:79]
    ds_read_b128 a[196:199], v60 offset:45056
    v_cvt_pk_bf16_f32 v207, v108, v109
    v_bfi_b32 v204, s30, v21, v204
    v_mfma_f32_16x16x32_bf16 v[76:79], a[164:167], a[4:7], v[76:79]
    ds_read_b128 a[160:163], v59 offset:51200
    buffer_store_dwordx4 v[204:207], v1, s[8:11], s89 offen offset:1024 sc1
    v_cvt_pk_bf16_f32 v208, v110, v110
    v_mfma_f32_16x16x32_bf16 v[80:83], a[168:171], a[0:3], v[80:83]
    ds_read_b128 a[164:167], v60 offset:51200
    v_cvt_pk_bf16_f32 v209, v111, v112
    v_cvt_pk_bf16_f32 v210, v113, v114
    v_mfma_f32_16x16x32_bf16 v[80:83], a[172:175], a[4:7], v[80:83]
    ds_read_b128 a[168:171], v59 offset:52224
    v_cvt_pk_bf16_f32 v211, v115, v115
    s_waitcnt lgkmcnt(5)
    v_mfma_f32_16x16x32_bf16 v[84:87], a[176:179], a[0:3], v[84:87]
    ds_read_b128 a[172:175], v60 offset:52224
    buffer_load_dwordx4 v1, s[8:11], s96 offen offset:3072 sc1 lds
    v_bfi_b32 v208, s30, v21, v208
    v_mfma_f32_16x16x32_bf16 v[84:87], a[180:183], a[4:7], v[84:87]
    ds_read_b128 a[176:179], v59 offset:53248
    v_mfma_f32_16x16x32_bf16 v[88:91], a[184:187], a[0:3], v[88:91]
    ds_read_b128 a[180:183], v60 offset:53248
    buffer_store_dwordx4 v[208:211], v1, s[8:11], s89 offen offset:2048 sc1
    s_xor_b32 s89, s2, 4
    s_lshl2_add_u32 s89, s89, s36
    s_mul_i32 s89, s89, 3072
    s_add_u32 s89, s89, 22151168
    v_mfma_f32_16x16x32_bf16 v[88:91], a[188:191], a[4:7], v[88:91]
    ds_read_b128 a[184:187], v59 offset:54272
    s_waitcnt lgkmcnt(5)
    v_mfma_f32_16x16x32_bf16 v[92:95], a[192:195], a[0:3], v[92:95]
    ds_read_b128 a[188:191], v60 offset:54272
    v_mfma_f32_16x16x32_bf16 v[92:95], a[196:199], a[4:7], v[92:95]
    ds_read_b128 a[192:195], v59 offset:55296
    s_add_u32 m0, s45, 106496
    s_nop 0
    buffer_load_dwordx4 v4, s[8:11], s96 offen sc1 lds
    s_waitcnt vmcnt(16)
    v_mfma_f32_16x16x32_bf16 v[76:79], a[160:163], a[8:11], v[76:79]
    ds_read_b128 a[196:199], v60 offset:55296
    v_mfma_f32_16x16x32_bf16 v[76:79], a[164:167], a[12:15], v[76:79]
    ds_read_b128 a[160:163], v16 offset:0
    s_waitcnt lgkmcnt(5)
    v_mfma_f32_16x16x32_bf16 v[80:83], a[168:171], a[8:11], v[80:83]
    ds_read_b128 a[164:167], v17 offset:0
    s_add_u32 s97, s47, 81920
    s_max_i32 s51, s94, 0
    s_mul_i32 s51, s51, 4096
    s_add_u32 s97, s97, s51
    v_mfma_f32_16x16x32_bf16 v[80:83], a[172:175], a[12:15], v[80:83]
    ds_read_b128 a[168:171], v16 offset:1024
    buffer_load_dwordx4 a[48:51], v1, s[8:11], s97 offen offset:0 sc1
    v_mfma_f32_16x16x32_bf16 v[84:87], a[176:179], a[8:11], v[84:87]
    ds_read_b128 a[172:175], v17 offset:1024
    v_mfma_f32_16x16x32_bf16 v[84:87], a[180:183], a[12:15], v[84:87]
    ds_read_b128 a[176:179], v16 offset:2048
    buffer_load_dwordx4 a[52:55], v1, s[8:11], s97 offen offset:1024 sc1
    s_waitcnt lgkmcnt(5)
    v_mfma_f32_16x16x32_bf16 v[88:91], a[184:187], a[8:11], v[88:91]
    ds_read_b128 a[180:183], v17 offset:2048
    v_mfma_f32_16x16x32_bf16 v[88:91], a[188:191], a[12:15], v[88:91]
    ds_read_b128 a[184:187], v16 offset:3072
    v_mfma_f32_16x16x32_bf16 v[92:95], a[192:195], a[8:11], v[92:95]
    ds_read_b128 a[188:191], v17 offset:3072
    v_mfma_f32_16x16x32_bf16 v[92:95], a[196:199], a[12:15], v[92:95]
    ds_read_b128 a[192:195], v16 offset:4096
    buffer_load_dwordx4 a[56:59], v1, s[8:11], s97 offen offset:2048 sc1
    s_waitcnt vmcnt(17) lgkmcnt(5)
    v_mfma_f32_16x16x32_bf16 v[76:79], a[160:163], a[16:19], v[76:79]
    ds_read_b128 a[196:199], v17 offset:4096
    v_mfma_f32_16x16x32_bf16 v[76:79], a[164:167], a[20:23], v[76:79]
    ds_read_b128 a[160:163], v16 offset:10240
    v_mfma_f32_16x16x32_bf16 v[80:83], a[168:171], a[16:19], v[80:83]
    ds_read_b128 a[164:167], v17 offset:10240
    v_mfma_f32_16x16x32_bf16 v[80:83], a[172:175], a[20:23], v[80:83]
    ds_read_b128 a[168:171], v16 offset:11264
    s_waitcnt lgkmcnt(5)
    v_mfma_f32_16x16x32_bf16 v[84:87], a[176:179], a[16:19], v[84:87]
    ds_read_b128 a[172:175], v17 offset:11264
    v_mfma_f32_16x16x32_bf16 v[84:87], a[180:183], a[20:23], v[84:87]
    ds_read_b128 a[176:179], v16 offset:12288
    v_mfma_f32_16x16x32_bf16 v[88:91], a[184:187], a[16:19], v[88:91]
    ds_read_b128 a[180:183], v17 offset:12288
    v_mfma_f32_16x16x32_bf16 v[88:91], a[188:191], a[20:23], v[88:91]
    ds_read_b128 a[184:187], v16 offset:13312
    s_waitcnt lgkmcnt(5)
    v_mfma_f32_16x16x32_bf16 v[92:95], a[192:195], a[16:19], v[92:95]
    ds_read_b128 a[188:191], v17 offset:13312
    v_mfma_f32_16x16x32_bf16 v[92:95], a[196:199], a[20:23], v[92:95]
    ds_read_b128 a[192:195], v16 offset:14336
    s_waitcnt vmcnt(15)
    v_mfma_f32_16x16x32_bf16 v[76:79], a[160:163], a[24:27], v[76:79]
    ds_read_b128 a[196:199], v17 offset:14336
    buffer_load_dwordx4 a[60:63], v1, s[8:11], s97 offen offset:3072 sc1
    v_mfma_f32_16x16x32_bf16 v[76:79], a[164:167], a[28:31], v[76:79]
    ds_read_b128 a[160:163], v16 offset:20480
    s_waitcnt lgkmcnt(5)
    v_mfma_f32_16x16x32_bf16 v[80:83], a[168:171], a[24:27], v[80:83]
    ds_read_b128 a[164:167], v17 offset:20480
    v_mfma_f32_16x16x32_bf16 v[80:83], a[172:175], a[28:31], v[80:83]
    ds_read_b128 a[168:171], v16 offset:21504
    s_add_u32 m0, s45, 122880
    s_add_u32 s96, s48, 225280
    s_min_i32 s51, s84, 0
    s_mul_i32 s51, s51, 20480
    s_add_u32 s96, s96, s51
    v_mfma_f32_16x16x32_bf16 v[84:87], a[176:179], a[24:27], v[84:87]
    ds_read_b128 a[172:175], v17 offset:21504
    buffer_load_dwordx4 v1, s[8:11], s96 offen sc1 lds
    v_mfma_f32_16x16x32_bf16 v[84:87], a[180:183], a[28:31], v[84:87]
    ds_read_b128 a[176:179], v16 offset:22528
    s_waitcnt lgkmcnt(5)
    v_mfma_f32_16x16x32_bf16 v[88:91], a[184:187], a[24:27], v[88:91]
    ds_read_b128 a[180:183], v17 offset:22528
    v_mfma_f32_16x16x32_bf16 v[88:91], a[188:191], a[28:31], v[88:91]
    ds_read_b128 a[184:187], v16 offset:23552
    v_mfma_f32_16x16x32_bf16 v[92:95], a[192:195], a[24:27], v[92:95]
    ds_read_b128 a[188:191], v17 offset:23552
    v_mfma_f32_16x16x32_bf16 v[92:95], a[196:199], a[28:31], v[92:95]
    ds_read_b128 a[192:195], v16 offset:24576
    buffer_load_dwordx4 v1, s[8:11], s96 offen offset:1024 sc1 lds
    s_waitcnt vmcnt(16) lgkmcnt(5)
    v_mfma_f32_16x16x32_bf16 v[76:79], a[160:163], a[32:35], v[76:79]
    ds_read_b128 a[196:199], v17 offset:24576
    v_mfma_f32_16x16x32_bf16 v[76:79], a[164:167], a[36:39], v[76:79]
    ds_read_b128 a[160:163], v16 offset:30720
    v_mfma_f32_16x16x32_bf16 v[80:83], a[168:171], a[32:35], v[80:83]
    ds_read_b128 a[164:167], v17 offset:30720
    v_mfma_f32_16x16x32_bf16 v[80:83], a[172:175], a[36:39], v[80:83]
    ds_read_b128 a[168:171], v16 offset:31744
    buffer_load_dwordx4 v1, s[8:11], s96 offen offset:2048 sc1 lds
    s_waitcnt lgkmcnt(5)
    v_mfma_f32_16x16x32_bf16 v[84:87], a[176:179], a[32:35], v[84:87]
    ds_read_b128 a[172:175], v17 offset:31744
    v_mfma_f32_16x16x32_bf16 v[84:87], a[180:183], a[36:39], v[84:87]
    ds_read_b128 a[176:179], v16 offset:32768
    v_mfma_f32_16x16x32_bf16 v[88:91], a[184:187], a[32:35], v[88:91]
    ds_read_b128 a[180:183], v17 offset:32768
    v_mfma_f32_16x16x32_bf16 v[88:91], a[188:191], a[36:39], v[88:91]
    ds_read_b128 a[184:187], v16 offset:33792
    s_waitcnt lgkmcnt(5)
    v_mfma_f32_16x16x32_bf16 v[92:95], a[192:195], a[32:35], v[92:95]
    ds_read_b128 a[188:191], v17 offset:33792
    v_mfma_f32_16x16x32_bf16 v[92:95], a[196:199], a[36:39], v[92:95]
    ds_read_b128 a[192:195], v16 offset:34816
    buffer_load_dwordx4 v1, s[8:11], s96 offen offset:3072 sc1 lds
    s_waitcnt vmcnt(16)
    v_mfma_f32_16x16x32_bf16 v[76:79], a[160:163], a[40:43], v[76:79]
    ds_read_b128 a[196:199], v17 offset:34816
    v_mfma_f32_16x16x32_bf16 v[76:79], a[164:167], a[44:47], v[76:79]
    s_add_u32 m0, s45, 126976
    s_nop 0
    buffer_load_dwordx4 v4, s[8:11], s96 offen sc1 lds
    s_add_u32 s97, s47, 86016
    s_min_i32 s51, s84, 0
    s_mul_i32 s51, s51, 4096
    s_add_u32 s97, s97, s51
    buffer_load_dwordx4 a[64:67], v1, s[8:11], s97 offen offset:0 sc1
    buffer_load_dwordx4 a[68:71], v1, s[8:11], s97 offen offset:1024 sc1
    s_waitcnt vmcnt(11)
    s_barrier
    ds_read_b128 a[160:163], v2 offset:40960
    s_waitcnt lgkmcnt(5)
    v_mfma_f32_16x16x32_bf16 v[80:83], a[168:171], a[40:43], v[80:83]
    ds_read_b128 a[164:167], v2 offset:46080
    buffer_load_dwordx4 a[72:75], v1, s[8:11], s97 offen offset:2048 sc1
    v_mfma_f32_16x16x32_bf16 v[80:83], a[172:175], a[44:47], v[80:83]
    ds_read_b128 a[168:171], v2 offset:41984
    v_mfma_f32_16x16x32_bf16 v[84:87], a[176:179], a[40:43], v[84:87]
    ds_read_b128 a[172:175], v2 offset:47104
    v_mfma_f32_16x16x32_bf16 v[84:87], a[180:183], a[44:47], v[84:87]
    ds_read_b128 a[176:179], v2 offset:43008
    s_waitcnt lgkmcnt(5)
    v_mfma_f32_16x16x32_bf16 v[88:91], a[184:187], a[40:43], v[88:91]
    ds_read_b128 a[180:183], v2 offset:48128
    buffer_load_dwordx4 a[76:79], v1, s[8:11], s97 offen offset:3072 sc1
    v_mfma_f32_16x16x32_bf16 v[88:91], a[188:191], a[44:47], v[88:91]
    ds_read_b128 a[184:187], v2 offset:44032
    v_mfma_f32_16x16x32_bf16 v[92:95], a[192:195], a[40:43], v[92:95]
    ds_read_b128 a[188:191], v2 offset:49152
    v_mfma_f32_16x16x32_bf16 v[92:95], a[196:199], a[44:47], v[92:95]
    ds_read_b128 a[192:195], v2 offset:45056
    s_waitcnt vmcnt(12) lgkmcnt(5)
    v_mfma_f32_16x16x32_bf16 v[216:219], a[160:163], a[48:51], 0
    s_waitcnt vmcnt(11)
    v_mfma_f32_16x16x32_bf16 v[216:219], a[164:167], a[52:55], v[216:219]
    v_mfma_f32_16x16x32_bf16 v[220:223], a[168:171], a[48:51], 0
    ds_read_b128 a[196:199], v2 offset:50176
    v_mfma_f32_16x16x32_bf16 v[220:223], a[172:175], a[52:55], v[220:223]
    ds_read_b128 a[160:163], v2 offset:51200
    s_waitcnt lgkmcnt(3)
    v_mfma_f32_16x16x32_bf16 v[224:227], a[176:179], a[48:51], 0
    ds_read_b128 a[164:167], v2 offset:56320
    buffer_load_dwordx4 v[200:203], v1, s[8:11], s89 offen offset:0 sc1
    v_mfma_f32_16x16x32_bf16 v[224:227], a[180:183], a[52:55], v[224:227]
    ds_read_b128 a[168:171], v2 offset:52224
    v_mfma_f32_16x16x32_bf16 v[228:231], a[184:187], a[48:51], 0
    ds_read_b128 a[172:175], v2 offset:57344
    buffer_load_dwordx4 v[204:207], v1, s[8:11], s89 offen offset:1024 sc1
    v_mfma_f32_16x16x32_bf16 v[228:231], a[188:191], a[52:55], v[228:231]
    ds_read_b128 a[176:179], v2 offset:53248
    s_waitcnt lgkmcnt(3)
    v_mfma_f32_16x16x32_bf16 v[232:235], a[192:195], a[48:51], 0
    ds_read_b128 a[180:183], v2 offset:58368
    buffer_load_dwordx4 v[208:211], v1, s[8:11], s89 offen offset:2048 sc1
    v_mfma_f32_16x16x32_bf16 v[232:235], a[196:199], a[52:55], v[232:235]
    ds_read_b128 a[184:187], v2 offset:54272
    s_waitcnt vmcnt(13)
    v_mfma_f32_16x16x32_bf16 v[216:219], a[160:163], a[56:59], v[216:219]
    ds_read_b128 a[188:191], v2 offset:59392
    s_waitcnt vmcnt(12)
    v_mfma_f32_16x16x32_bf16 v[216:219], a[164:167], a[60:63], v[216:219]
    ds_read_b128 a[192:195], v2 offset:55296
    s_waitcnt lgkmcnt(3)
    v_mfma_f32_16x16x32_bf16 v[220:223], a[168:171], a[56:59], v[220:223]
    ds_read_b128 a[196:199], v2 offset:60416
    v_mfma_f32_16x16x32_bf16 v[220:223], a[172:175], a[60:63], v[220:223]
    s_waitcnt vmcnt(7)
    s_barrier
    ds_read_b128 a[160:163], v3 offset:0
    v_mfma_f32_16x16x32_bf16 v[224:227], a[176:179], a[56:59], v[224:227]
    ds_read_b128 a[164:167], v3 offset:1024
    v_mfma_f32_16x16x32_bf16 v[224:227], a[180:183], a[60:63], v[224:227]
    ds_read_b128 a[168:171], v3 offset:2048
    s_waitcnt lgkmcnt(3)
    v_mfma_f32_16x16x32_bf16 v[228:231], a[184:187], a[56:59], v[228:231]
    ds_read_b128 a[172:175], v3 offset:3072
    v_mfma_f32_16x16x32_bf16 v[228:231], a[188:191], a[60:63], v[228:231]
    ds_read_b128 a[176:179], v3 offset:4096
    v_mfma_f32_16x16x32_bf16 v[232:235], a[192:195], a[56:59], v[232:235]
    ds_read_b128 a[180:183], v3 offset:5120
    v_mfma_f32_16x16x32_bf16 v[232:235], a[196:199], a[60:63], v[232:235]
    ds_read_b128 a[184:187], v3 offset:6144
    s_waitcnt vmcnt(6) lgkmcnt(3)
    v_mfma_f32_16x16x32_bf16 v[216:219], a[160:163], a[64:67], v[216:219]
    ds_read_b128 a[188:191], v3 offset:7168
    v_mfma_f32_16x16x32_bf16 v[220:223], a[164:167], a[64:67], v[220:223]
    ds_read_b128 a[192:195], v3 offset:8192
    v_mfma_f32_16x16x32_bf16 v[224:227], a[168:171], a[64:67], v[224:227]
    ds_read_b128 a[196:199], v3 offset:9216
    v_mfma_f32_16x16x32_bf16 v[228:231], a[172:175], a[64:67], v[228:231]
    ds_read_b128 a[160:163], v3 offset:10240
    s_waitcnt lgkmcnt(3)
    v_mfma_f32_16x16x32_bf16 v[232:235], a[176:179], a[64:67], v[232:235]
    ds_read_b128 a[164:167], v3 offset:11264
    s_waitcnt vmcnt(5)
    v_mfma_f32_16x16x32_bf16 v[216:219], a[180:183], a[68:71], v[216:219]
L_pad6:
    s_cbranch_execz L_back
    ds_read_b128 a[168:171], v3 offset:12288
    v_mfma_f32_16x16x32_bf16 v[220:223], a[184:187], a[68:71], v[220:223]
    ds_read_b128 a[172:175], v3 offset:13312
    v_mfma_f32_16x16x32_bf16 v[224:227], a[188:191], a[68:71], v[224:227]
    ds_read_b128 a[176:179], v3 offset:14336
    s_waitcnt lgkmcnt(3)
    v_mfma_f32_16x16x32_bf16 v[228:231], a[192:195], a[68:71], v[228:231]
    ds_read_b128 a[180:183], v3 offset:15360
    v_mfma_f32_16x16x32_bf16 v[232:235], a[196:199], a[68:71], v[232:235]
    ds_read_b128 a[184:187], v3 offset:16384
    s_waitcnt vmcnt(4)
    v_mfma_f32_16x16x32_bf16 v[216:219], a[160:163], a[72:75], v[216:219]
    ds_read_b128 a[188:191], v3 offset:17408
    v_mfma_f32_16x16x32_bf16 v[220:223], a[164:167], a[72:75], v[220:223]
    ds_read_b128 a[192:195], v3 offset:18432
    s_waitcnt lgkmcnt(3)
    v_mfma_f32_16x16x32_bf16 v[224:227], a[168:171], a[72:75], v[224:227]
    ds_read_b128 a[196:199], v3 offset:19456
    v_mfma_f32_16x16x32_bf16 v[228:231], a[172:175], a[72:75], v[228:231]
    v_mfma_f32_16x16x32_bf16 v[232:235], a[176:179], a[72:75], v[232:235]
    s_waitcnt vmcnt(3)
    v_mfma_f32_16x16x32_bf16 v[216:219], a[180:183], a[76:79], v[216:219]
    s_waitcnt lgkmcnt(0)
    v_mfma_f32_16x16x32_bf16 v[220:223], a[184:187], a[76:79], v[220:223]
    v_mfma_f32_16x16x32_bf16 v[224:227], a[188:191], a[76:79], v[224:227]
    v_mfma_f32_16x16x32_bf16 v[228:231], a[192:195], a[76:79], v[228:231]
    v_mfma_f32_16x16x32_bf16 v[232:235], a[196:199], a[76:79], v[232:235]
    s_waitcnt vmcnt(0)
    v_bitop3_b32 v212, v200, v204, s42 bitop3:126
    v_bitop3_b32 v212, v212, v208, s42 bitop3:246
    v_and_b32 v212, 0xffff, v212
    v_cmp_ne_u32 vcc, 0, v212
    s_cbranch_vccnz L_slow7
L_ok7:
    s_cmp_eq_u32 s41, 1
    s_cbranch_scc0 L_zr_c
    v_pk_add_f32 v[216:217], v[216:217], v[76:77]
    v_pk_add_f32 v[218:219], v[218:219], v[78:79]
    v_pk_add_f32 v[220:221], v[220:221], v[80:81]
    v_pk_add_f32 v[222:223], v[222:223], v[82:83]
    v_pk_add_f32 v[224:225], v[224:225], v[84:85]
    v_pk_add_f32 v[226:227], v[226:227], v[86:87]
    v_pk_add_f32 v[228:229], v[228:229], v[88:89]
    v_pk_add_f32 v[230:231], v[230:231], v[90:91]
    v_pk_add_f32 v[232:233], v[232:233], v[92:93]
    v_pk_add_f32 v[234:235], v[234:235], v[94:95]
    v_and_b32 v76, 0xffff0000, v200
    v_lshlrev_b32 v77, 16, v201
    v_and_b32 v78, 0xffff0000, v201
    v_lshlrev_b32 v79, 16, v202
    v_and_b32 v80, 0xffff0000, v202
    v_lshlrev_b32 v81, 16, v203
    v_and_b32 v82, 0xffff0000, v203
    v_and_b32 v83, 0xffff0000, v204
    v_lshlrev_b32 v84, 16, v205
    v_and_b32 v85, 0xffff0000, v205
    v_lshlrev_b32 v86, 16, v206
    v_and_b32 v87, 0xffff0000, v206
    v_lshlrev_b32 v88, 16, v207
    v_and_b32 v89, 0xffff0000, v207
    v_and_b32 v90, 0xffff0000, v208
    v_lshlrev_b32 v91, 16, v209
    v_and_b32 v92, 0xffff0000, v209
    v_lshlrev_b32 v93, 16, v210
    v_and_b32 v94, 0xffff0000, v210
    v_lshlrev_b32 v95, 16, v211
    s_branch L_zr_j
L_zr_c:
    v_and_b32 v96, 0xffff0000, v200
    v_lshlrev_b32 v97, 16, v201
    v_and_b32 v98, 0xffff0000, v201
    v_lshlrev_b32 v99, 16, v202
    v_and_b32 v100, 0xffff0000, v202
    v_lshlrev_b32 v101, 16, v203
    v_and_b32 v102, 0xffff0000, v203
    v_and_b32 v103, 0xffff0000, v204
    v_lshlrev_b32 v104, 16, v205
    v_and_b32 v105, 0xffff0000, v205
    v_lshlrev_b32 v106, 16, v206
    v_and_b32 v107, 0xffff0000, v206
    v_lshlrev_b32 v108, 16, v207
    v_and_b32 v109, 0xffff0000, v207
    v_and_b32 v110, 0xffff0000, v208
    v_lshlrev_b32 v111, 16, v209
    v_and_b32 v112, 0xffff0000, v209
    v_lshlrev_b32 v113, 16, v210
    v_and_b32 v114, 0xffff0000, v210
    v_lshlrev_b32 v115, 16, v211
    v_pk_add_f32 v[216:217], v[216:217], v[96:97]
    v_pk_add_f32 v[218:219], v[218:219], v[98:99]
    v_pk_add_f32 v[220:221], v[220:221], v[100:101]
    v_pk_add_f32 v[222:223], v[222:223], v[102:103]
    v_pk_add_f32 v[224:225], v[224:225], v[104:105]
    v_pk_add_f32 v[226:227], v[226:227], v[106:107]
    v_pk_add_f32 v[228:229], v[228:229], v[108:109]
    v_pk_add_f32 v[230:231], v[230:231], v[110:111]
    v_pk_add_f32 v[232:233], v[232:233], v[112:113]
    v_pk_add_f32 v[234:235], v[234:235], v[114:115]
L_zr_j:
    v_pk_mul_f32 v[180:181], v[216:217], s[28:29]
    v_pk_mul_f32 v[182:183], v[218:219], s[28:29]
    v_exp_f32 v180, v180
    v_exp_f32 v181, v181
    v_exp_f32 v182, v182
    v_exp_f32 v183, v183
    v_pk_add_f32 v[180:181], v[180:181], 1.0 op_sel_hi:[1,0]
    v_pk_add_f32 v[182:183], v[182:183], 1.0 op_sel_hi:[1,0]
    v_rcp_f32 v180, v180
    v_rcp_f32 v181, v181
    v_rcp_f32 v182, v182
    v_rcp_f32 v183, v183
    v_pk_mul_f32 v[216:217], v[216:217], v[180:181]
    v_pk_mul_f32 v[218:219], v[218:219], v[182:183]
    v_pk_fma_f32 v[128:129], v[76:77], v[216:217], v[128:129]
    v_pk_fma_f32 v[130:131], v[78:79], v[218:219], v[130:131]
    v_pk_fma_f32 v[160:161], v[160:161], v[216:217], v[128:129]
    v_pk_fma_f32 v[162:163], v[162:163], v[218:219], v[130:131]
    ds_write_b128 v153, v[160:163] offset:0
    v_pk_mul_f32 v[184:185], v[220:221], s[28:29]
    v_pk_mul_f32 v[186:187], v[222:223], s[28:29]
    v_exp_f32 v184, v184
    v_exp_f32 v185, v185
    v_exp_f32 v186, v186
    v_exp_f32 v187, v187
    v_pk_add_f32 v[184:185], v[184:185], 1.0 op_sel_hi:[1,0]
    v_pk_add_f32 v[186:187], v[186:187], 1.0 op_sel_hi:[1,0]
    v_rcp_f32 v184, v184
    v_rcp_f32 v185, v185
    v_rcp_f32 v186, v186
    v_rcp_f32 v187, v187
    v_pk_mul_f32 v[220:221], v[220:221], v[184:185]
    v_pk_mul_f32 v[222:223], v[222:223], v[186:187]
    v_pk_fma_f32 v[132:133], v[80:81], v[220:221], v[132:133]
    v_pk_fma_f32 v[134:135], v[82:83], v[222:223], v[134:135]
    v_pk_fma_f32 v[164:165], v[164:165], v[220:221], v[132:133]
    v_pk_fma_f32 v[166:167], v[166:167], v[222:223], v[134:135]
    ds_write_b128 v153, v[164:167] offset:64
    v_pk_mul_f32 v[188:189], v[224:225], s[28:29]
    v_pk_mul_f32 v[190:191], v[226:227], s[28:29]
    v_exp_f32 v188, v188
    v_exp_f32 v189, v189
    v_exp_f32 v190, v190
    v_exp_f32 v191, v191
    v_pk_add_f32 v[188:189], v[188:189], 1.0 op_sel_hi:[1,0]
    v_pk_add_f32 v[190:191], v[190:191], 1.0 op_sel_hi:[1,0]
    v_rcp_f32 v188, v188
    v_rcp_f32 v189, v189
    v_rcp_f32 v190, v190
    v_rcp_f32 v191, v191
    v_pk_mul_f32 v[224:225], v[224:225], v[188:189]
    v_pk_mul_f32 v[226:227], v[226:227], v[190:191]
    v_pk_fma_f32 v[136:137], v[84:85], v[224:225], v[136:137]
    v_pk_fma_f32 v[138:139], v[86:87], v[226:227], v[138:139]
    v_pk_fma_f32 v[168:169], v[168:169], v[224:225], v[136:137]
    v_pk_fma_f32 v[170:171], v[170:171], v[226:227], v[138:139]
    ds_write_b128 v153, v[168:171] offset:128
    v_pk_mul_f32 v[192:193], v[228:229], s[28:29]
    v_pk_mul_f32 v[194:195], v[230:231], s[28:29]
    v_exp_f32 v192, v192
    v_exp_f32 v193, v193
    v_exp_f32 v194, v194
    v_exp_f32 v195, v195
    v_pk_add_f32 v[192:193], v[192:193], 1.0 op_sel_hi:[1,0]
    v_pk_add_f32 v[194:195], v[194:195], 1.0 op_sel_hi:[1,0]
    v_rcp_f32 v192, v192
    v_rcp_f32 v193, v193
    v_rcp_f32 v194, v194
    v_rcp_f32 v195, v195
    v_pk_mul_f32 v[228:229], v[228:229], v[192:193]
    v_pk_mul_f32 v[230:231], v[230:231], v[194:195]
    v_pk_fma_f32 v[140:141], v[88:89], v[228:229], v[140:141]
    v_pk_fma_f32 v[142:143], v[90:91], v[230:231], v[142:143]
    v_pk_fma_f32 v[172:173], v[172:173], v[228:229], v[140:141]
    v_pk_fma_f32 v[174:175], v[174:175], v[230:231], v[142:143]
    ds_write_b128 v153, v[172:175] offset:192
    v_pk_mul_f32 v[196:197], v[232:233], s[28:29]
    v_pk_mul_f32 v[198:199], v[234:235], s[28:29]
    v_exp_f32 v196, v196
    v_exp_f32 v197, v197
    v_exp_f32 v198, v198
    v_exp_f32 v199, v199
    v_pk_add_f32 v[196:197], v[196:197], 1.0 op_sel_hi:[1,0]
    v_pk_add_f32 v[198:199], v[198:199], 1.0 op_sel_hi:[1,0]
    v_rcp_f32 v196, v196
    v_rcp_f32 v197, v197
    v_rcp_f32 v198, v198
    v_rcp_f32 v199, v199
    v_pk_mul_f32 v[232:233], v[232:233], v[196:197]
    v_pk_mul_f32 v[234:235], v[234:235], v[198:199]
    v_pk_fma_f32 v[144:145], v[92:93], v[232:233], v[144:145]
    v_pk_fma_f32 v[146:147], v[94:95], v[234:235], v[146:147]
    v_pk_fma_f32 v[176:177], v[176:177], v[232:233], v[144:145]
    v_pk_fma_f32 v[178:179], v[178:179], v[234:235], v[146:147]
    ds_write_b128 v153, v[176:179] offset:256
    ds_read_b128 v[180:183], v154
    ds_read_b128 v[184:187], v155
    ds_read_b128 v[188:191], v156
    ds_read_b128 v[192:195], v157
    ds_read_b128 v[196:199], v158
    s_waitcnt lgkmcnt(4)
    buffer_store_dwordx4 v[180:183], v148, s[12:15], s99 offen sc1 nt
    s_waitcnt lgkmcnt(3)
    buffer_store_dwordx4 v[184:187], v149, s[12:15], s99 offen sc1 nt
    s_waitcnt lgkmcnt(2)
    buffer_store_dwordx4 v[188:191], v150, s[12:15], s99 offen sc1 nt
    s_waitcnt lgkmcnt(1)
    buffer_store_dwordx4 v[192:195], v151, s[12:15], s99 offen sc1 nt
    s_waitcnt lgkmcnt(0)
    buffer_store_dwordx4 v[196:199], v152, s[12:15], s99 offen sc1 nt
L_end:
    s_endpgm
L_slow0:
    s_mov_b32 s60, 0
L_spin0:
    s_sleep 4
    buffer_load_dword v79, v78, s[8:11], s3 offen offset:0 sc1
    s_waitcnt vmcnt(0)
    v_cmp_ne_u32 vcc, s42, v79
    s_cbranch_vccz L_ok0
    s_add_u32 s60, s60, 1
    s_cmp_lt_u32 s60, 0x40000
    s_cbranch_scc1 L_spin0
    s_branch L_ok0
L_slow1:
    s_mov_b32 s60, 0
L_spin1:
    s_sleep 4
    buffer_load_dword v212, v213, s[8:11], s57 offen offset:0 sc1
    s_waitcnt vmcnt(0)
    v_cmp_ne_u32 vcc, s42, v212
    s_cbranch_vccz L_ok1
    s_add_u32 s60, s60, 1
    s_cmp_lt_u32 s60, 0x40000
    s_cbranch_scc1 L_spin1
    s_branch L_ok1
L_slow2:
    s_mov_b32 s60, 0
L_spin2:
    s_sleep 4
    buffer_load_dwordx2 v[196:197], v62, s[8:11], s58 offen offset:0 sc1
    buffer_load_dwordx2 v[198:199], v62, s[8:11], s58 offen offset:640 sc1
    buffer_load_dwordx2 v[200:201], v62, s[8:11], s58 offen offset:1280 sc1
    buffer_load_dwordx2 v[202:203], v62, s[8:11], s58 offen offset:1920 sc1
    buffer_load_dwordx2 v[204:205], v62, s[8:11], s58 offen offset:2560 sc1
    s_waitcnt vmcnt(0)
    v_bitop3_b32 v197, v197, v199, s42 bitop3:126
    v_bitop3_b32 v197, v197, v201, s42 bitop3:246
    v_bitop3_b32 v197, v197, v203, s42 bitop3:246
    v_bitop3_b32 v197, v197, v205, s42 bitop3:246
    v_cmp_ne_u32 vcc, 0, v197
    s_cbranch_vccz L_ok2
    s_add_u32 s60, s60, 1
    s_cmp_lt_u32 s60, 0x40000
    s_cbranch_scc1 L_spin2
    s_branch L_ok2
L_slow3:
    s_mov_b32 s60, 0
L_spin3:
    s_sleep 4
    buffer_load_dwordx4 v[212:215], v1, s[8:11], s0 offen offset:0 sc1
    s_waitcnt vmcnt(0)
    v_bitop3_b32 v212, v212, v213, s42 bitop3:126
    v_bitop3_b32 v212, v212, v214, s42 bitop3:246
    v_bitop3_b32 v212, v212, v215, s42 bitop3:246
    v_cmp_ne_u32 vcc, 0, v212
    s_cbranch_vccz L_ok3
    s_add_u32 s60, s60, 1
    s_cmp_lt_u32 s60, 0x40000
    s_cbranch_scc1 L_spin3
    s_branch L_ok3
L_slow4:
    s_mov_b32 s60, 0
L_spin4:
    s_sleep 4
    buffer_load_dword v212, v68, s[8:11], s0 offen offset:0 sc1
    s_waitcnt vmcnt(0)
    v_cmp_ne_u32 vcc, s42, v212
    s_cbranch_vccz L_ok4
    s_add_u32 s60, s60, 1
    s_cmp_lt_u32 s60, 0x40000
    s_cbranch_scc1 L_spin4
    s_branch L_ok4
L_slow5:
    s_mov_b32 s60, 0
L_spin5:
    s_sleep 4
    buffer_load_dword v212, v68, s[8:11], s0 offen offset:0 sc1
    s_waitcnt vmcnt(0)
    v_cmp_ne_u32 vcc, s42, v212
    s_cbranch_vccz L_ok5
    s_add_u32 s60, s60, 1
    s_cmp_lt_u32 s60, 0x40000
    s_cbranch_scc1 L_spin5
    s_branch L_ok5
L_slow6:
    s_mov_b32 s60, 0
L_spin6:
    s_sleep 4
    buffer_load_dword v212, v68, s[8:11], s0 offen offset:0 sc1
    s_waitcnt vmcnt(0)
    v_cmp_ne_u32 vcc, s42, v212
    s_cbranch_vccz L_ok6
    s_add_u32 s60, s60, 1
    s_cmp_lt_u32 s60, 0x40000
    s_cbranch_scc1 L_spin6
    s_branch L_ok6
L_slow7:
    s_mov_b32 s60, 0
L_spin7:
    s_sleep 4
    buffer_load_dwordx4 v[200:203], v1, s[8:11], s89 offen offset:0 sc1
    buffer_load_dwordx4 v[204:207], v1, s[8:11], s89 offen offset:1024 sc1
    buffer_load_dwordx4 v[208:211], v1, s[8:11], s89 offen offset:2048 sc1
    s_waitcnt vmcnt(0)
    v_bitop3_b32 v212, v200, v204, s42 bitop3:126
    v_bitop3_b32 v212, v212, v208, s42 bitop3:246
    v_and_b32 v212, 0xffff, v212
    v_cmp_ne_u32 vcc, 0, v212
    s_cbranch_vccz L_ok7
    s_add_u32 s60, s60, 1
    s_cmp_lt_u32 s60, 0x40000
    s_cbranch_scc1 L_spin7
    s_branch L_ok7
L_code_end:
    s_endpgm
.section .rodata,"a"
.p2align 6
.amdhsa_kernel recurrent_scan__ssm_conv_s5__glu_gated_glu__prompt_kernel
  .amdhsa_next_free_vgpr 512
  .amdhsa_next_free_sgpr 102
  .amdhsa_accum_offset 256
  .amdhsa_group_segment_fixed_size 0
  .amdhsa_kernarg_size 128
  .amdhsa_user_sgpr_count 2
  .amdhsa_user_sgpr_kernarg_segment_ptr 1
  .amdhsa_system_sgpr_workgroup_id_x 1
.end_amdhsa_kernel
```
